```python
import torch

def _softmax(x, axis=-1):
    return torch.softmax(x, dim=axis)
def _gelu(x):
    return torch.nn.functional.gelu(x, approximate="tanh")
def _silu(x):
    return torch.nn.functional.silu(x)
def _sigmoid(x):
    return torch.sigmoid(x)
def _layernorm(x, axis=-1, eps=1e-5):
    m = x.mean(dim=axis, keepdim=True)
    v = x.var(dim=axis, keepdim=True, unbiased=False)
    return (x - m) / torch.sqrt(v + eps)
def _scatter_add(tgt, idx, src, axis=0):
    return tgt.clone().index_add_(axis, idx, src)
def _segment_sum(src, seg, n):
    out = torch.zeros((n,) + src.shape[1:], dtype=src.dtype)
    return out.index_add_(0, seg, src)
def _pad(x, pw):
    flat = tuple(v for pair in reversed(pw) for v in pair)
    return torch.nn.functional.pad(x, flat)

kernel_name = 'standalone__normalfloat_lut_nf4__prompt'

def setup_inputs():

    _w = (lambda a: (lambda t: t.to(torch.bfloat16) if t.is_floating_point() else t)(torch.as_tensor(a)))
    B, S, D, F = 1, 2048, 576, 4608
    G = 128 if 128 > 0 else D
    D = (D // G) * G
    ng = D // G
    qw = torch.randint(0, 16, (D, F)).to(torch.int64)
    return {
        "x": _w((lambda *s: torch.randn(*s, dtype=torch.bfloat16) * 0.05)(B, S, D)),
        "qw": _w(qw),
        "absmax": _w(torch.abs((lambda *s: torch.randn(*s, dtype=torch.bfloat16) * 0.05)(ng, F)).to(float) + 0.01),
    }

def reference(x, qw, absmax):
    NF4 = torch.as_tensor([
        -1.0, -0.6961928009986877, -0.5250730514526367, -0.39491748809814453,
        -0.28444138169288635, -0.18477343022823334, -0.09105003625154495, 0.0,
        0.07958029955625534, 0.16093020141124725, 0.24611230194568634,
        0.33791524171829224, 0.44070982933044434, 0.5626170039176941,
        0.7229568362236023, 1.0,
    ])
    D, F = qw.shape[0], qw.shape[1]
    ng = absmax.shape[0]
    G = D // ng
    w = (lambda x, dt: x.to(dt))(NF4[qw], x.dtype)
    s = (lambda x, n, axis: torch.repeat_interleave(x, n, dim=axis))(absmax, G, axis=0)
    w = w * s
    return torch.einsum("bsd,df->bsf", x, w)
```

```asm
; @launch grid=(256,1,1) block=(256,1,1) lds=155648
.amdgcn_target "amdgcn-amd-amdhsa--gfx950"
.text
.globl standalone__normalfloat_lut_nf4__prompt_kernel
.p2align 8
.type standalone__normalfloat_lut_nf4__prompt_kernel,@function
standalone__normalfloat_lut_nf4__prompt_kernel:
    s_load_dwordx4 s[4:7], s[0:1], 0
    s_load_dwordx4 s[8:11], s[0:1], 16
    s_cmp_ge_u32 s2, 252
    s_cbranch_scc1 L_pf0_standalone__normalfloat_lut_nf4__prompt_kernel
    s_getpc_b64 s[80:81]
L_pc_standalone__normalfloat_lut_nf4__prompt_kernel:
    s_and_b32 s80, s80, 0xffffff80
    s_mov_b32 s82, L_end_standalone__normalfloat_lut_nf4__prompt_kernel-L_pc_standalone__normalfloat_lut_nf4__prompt_kernel+2048
    s_mov_b32 s83, 0x20000
    s_lshr_b32 s71, s2, 3
    s_lshl_b32 s71, s71, 10
    v_lshrrev_b32 v32, 5, v0
    v_lshlrev_b32 v32, 7, v32
    buffer_load_dword v33, v32, s[80:83], s71 offen
    v_lshrrev_b32 v2, 6, v0
    v_and_b32 v1, 63, v0
    v_readfirstlane_b32 s3, v2
    s_and_b32 s62, s2, 3
    s_mul_i32 s62, s62, 63
    s_bfe_u32 s63, s2, 0x10002
    s_lshl_b32 s63, s63, 5
    s_lshr_b32 s64, s2, 3
    s_add_u32 s62, s62, s63
    s_add_u32 s62, s62, s64
    s_mul_i32 s77, s62, 9363
    s_lshr_b32 s77, s77, 16
    s_mul_i32 s63, s77, 7
    s_sub_u32 s78, s62, s63
    s_add_u32 s54, s78, s2
    s_and_b32 s58, s54, 1
    s_bfe_u32 s54, s54, 0x10001
    s_and_b32 s55, s3, 1
    s_lshr_b32 s56, s3, 1
    v_and_b32 v2, 15, v0
    v_lshrrev_b32 v3, 4, v1
    v_mul_u32_u24 v4, 147456, v3
    v_lshl_add_u32 v4, v2, 4, v4
    s_lshl_b32 s65, s77, 1
    s_add_u32 s65, s65, s55
    s_lshl_b32 s66, s65, 8
    s_mul_i32 s67, s56, 4718592
    s_add_u32 s66, s66, s67
    s_mul_i32 s67, s54, 1179648
    s_add_u32 s67, s67, s66
    s_mov_b32 s22, 1161472
    s_mov_b32 s23, 0x20000
    s_mul_i32 s36, s58, 589824
    s_movk_i32 s73, 18432
    s_add_u32 s37, s36, s73
    s_add_u32 s38, s37, s73
    s_add_u32 s39, s38, s73
    s_add_u32 s40, s39, s73
    s_add_u32 s41, s40, s73
    s_add_u32 s42, s41, s73
    s_add_u32 s43, s42, s73
    s_waitcnt lgkmcnt(0)
    s_add_u32 s20, s6, s67
    s_addc_u32 s21, s7, 0
    tbuffer_load_format_d16_xyzw v[128:129], v4, s[20:23], s36 format:[BUF_DATA_FORMAT_32_32_32_32,BUF_NUM_FORMAT_UINT] offen
    tbuffer_load_format_d16_xyzw v[132:133], v4, s[20:23], s37 format:[BUF_DATA_FORMAT_32_32_32_32,BUF_NUM_FORMAT_UINT] offen
    tbuffer_load_format_d16_xyzw v[136:137], v4, s[20:23], s38 format:[BUF_DATA_FORMAT_32_32_32_32,BUF_NUM_FORMAT_UINT] offen
    tbuffer_load_format_d16_xyzw v[140:141], v4, s[20:23], s39 format:[BUF_DATA_FORMAT_32_32_32_32,BUF_NUM_FORMAT_UINT] offen
    tbuffer_load_format_d16_xyzw v[130:131], v4, s[20:23], s40 format:[BUF_DATA_FORMAT_32_32_32_32,BUF_NUM_FORMAT_UINT] offen
    s_lshl_b32 s62, s65, 7
    s_add_u32 s80, s8, s62
    s_addc_u32 s81, s9, 0
    s_movk_i32 s82, 27776
    s_mov_b32 s83, 0x20000
    s_lshr_b32 s63, s54, 1
    s_lshl_b32 s64, s56, 1
    s_add_u32 s63, s63, s64
    s_xor_b32 s64, s63, 1
    s_mulk_i32 s63, 9216
    s_mulk_i32 s64, 9216
    v_lshlrev_b32 v18, 3, v2
    buffer_load_dwordx2 v[64:65], v18, s[80:83], s63 offen
    buffer_load_dwordx2 v[66:67], v18, s[80:83], s64 offen
    s_mul_i32 s57, s78, 18
    s_min_u32 s63, s78, 2
    s_add_u32 s57, s57, s63
    s_lshl_b32 s63, s57, 14
    s_add_u32 s80, s4, s63
    s_addc_u32 s81, s5, 0
    s_cmp_lt_u32 s78, 2
    s_cselect_b32 s82, 19, 18
    s_lshl_b32 s82, s82, 14
    s_lshl_b32 s63, s77, 2
    s_add_u32 s63, s63, s3
    s_lshl_b32 s63, s63, 11
    s_bfe_u32 s64, s77, 0x10001
    s_lshl_b32 s64, s64, 9
    s_add_u32 s64, s64, s63
    v_bfe_u32 v32, v1, 2, 1
    v_lshlrev_b32 v32, 3, v32
    v_and_or_b32 v32, v1, 3, v32
    v_lshl_add_u32 v32, v32, 7, s64
    s_lshl_b32 s64, s77, 2
    s_add_u32 s64, s64, s3
    s_lshl_b32 s64, s64, 7
    s_add_u32 s64, s64, 294912
    v_mov_b32 v34, s64
    v_cmp_gt_u32 vcc, 8, v1
    s_nop 1
    v_cndmask_b32 v32, v34, v32, vcc
    buffer_load_dword v68, v32, s[80:83], 0 offen
    tbuffer_load_format_d16_xyzw v[134:135], v4, s[20:23], s41 format:[BUF_DATA_FORMAT_32_32_32_32,BUF_NUM_FORMAT_UINT] offen
    tbuffer_load_format_d16_xyzw v[138:139], v4, s[20:23], s42 format:[BUF_DATA_FORMAT_32_32_32_32,BUF_NUM_FORMAT_UINT] offen
    tbuffer_load_format_d16_xyzw v[142:143], v4, s[20:23], s43 format:[BUF_DATA_FORMAT_32_32_32_32,BUF_NUM_FORMAT_UINT] offen
    s_sub_u32 s44, 589824, s36
    s_add_u32 s45, s44, s73
    s_add_u32 s46, s45, s73
    s_add_u32 s47, s46, s73
    s_add_u32 s48, s47, s73
    s_add_u32 s49, s48, s73
    s_add_u32 s50, s49, s73
    s_add_u32 s51, s50, s73
    s_xor_b32 s63, s54, 1
    s_mul_i32 s63, s63, 1179648
    s_add_u32 s63, s63, s66
    s_add_u32 s24, s6, s63
    s_addc_u32 s25, s7, 0
    s_mov_b64 s[26:27], s[22:23]
    s_xor_b32 s63, s54, 2
    s_mul_i32 s63, s63, 1179648
    s_add_u32 s63, s63, s66
    s_add_u32 s28, s6, s63
    s_addc_u32 s29, s7, 0
    s_mov_b64 s[30:31], s[22:23]
    s_xor_b32 s63, s54, 3
    s_mul_i32 s63, s63, 1179648
    s_add_u32 s63, s63, s66
    s_add_u32 s32, s6, s63
    s_addc_u32 s33, s7, 0
    s_mov_b64 s[34:35], s[22:23]
    s_mul_i32 s57, s78, 18
    s_min_u32 s63, s78, 2
    s_add_u32 s57, s57, s63
    s_mul_i32 s63, s57, 147456
    s_add_u32 s63, s63, s62
    s_add_u32 s12, s10, s63
    s_addc_u32 s13, s11, 0
    s_mov_b32 s14, 2645120
    s_mov_b32 s15, s23
    s_mov_b64 s[16:17], s[12:13]
    s_mov_b32 s19, s23
    s_lshl_b32 s63, s55, 13
    s_lshl_b32 s64, s56, 9
    s_add_u32 s63, s63, s64
    s_lshl_b32 s64, s57, 14
    s_add_u32 s64, s64, s63
    s_add_u32 s4, s4, s64
    s_addc_u32 s5, s5, 0
    s_sub_u32 s6, 294912, s63
    s_mov_b32 s7, s23
    s_mov_b64 s[8:9], s[4:5]
    s_add_u32 s64, s6, 16384
    s_cmp_lt_u32 s78, 2
    s_cselect_b32 s10, s64, 0
    s_cselect_b32 s18, 2792576, 0
    s_mov_b32 s11, s23
    v_lshl_add_u32 v32, s55, 2, v3
    v_and_b32 v35, 7, v1
    v_xor_b32 v32, v32, v35
    v_lshrrev_b32 v35, 3, v1
    v_lshlrev_b32 v35, 10, v35
    v_lshl_add_u32 v32, v32, 4, v35
    v_lshl_add_u32 v5, s54, 7, v32
    v_xor_b32 v6, 128, v5
    v_xor_b32 v7, 256, v5
    v_xor_b32 v8, 384, v5
    s_lshl_b32 s72, s3, 10
    s_movk_i32 s73, 0x1000
    s_mov_b32 s74, 8388616
    s_mul_i32 s75, s56, 0x110
    s_mul_i32 s76, s56, 18432
    s_add_u32 s76, s76, 2654208
    v_lshrrev_b32 v32, 1, v2
    v_xor_b32 v32, v32, v3
    v_lshlrev_b32 v32, 4, v32
    v_lshl_add_u32 v32, v2, 7, v32
    v_lshl_add_u32 v9, s56, 11, v32
    s_lshl_b32 s58, s58, 6
    v_xor_b32 v9, s58, v9
    v_xor_b32 v10, 64, v9
    v_add_u32 v11, 0x10000, v9
    v_add_u32 v12, 0x10000, v10
    s_lshl_b32 s52, s56, 14
    s_mov_b32 s2, 0x8000
    s_add_u32 s53, s52, s2
    s_add_u32 s54, s53, s2
    s_add_u32 s55, s54, s2
    s_add_u32 s56, s55, s2
    s_add_u32 s57, s56, s2
    s_add_u32 s58, s57, s2
    s_add_u32 s59, s58, s2
    s_add_u32 s60, s59, s2
    s_mov_b32 s61, 294912
    s_movk_i32 s2, 0x4000
    s_xor_b32 s62, s52, s2
    s_xor_b32 s63, s53, s2
    s_xor_b32 s64, s54, s2
    s_xor_b32 s65, s55, s2
    s_xor_b32 s66, s56, s2
    s_xor_b32 s67, s57, s2
    s_xor_b32 s68, s58, s2
    s_xor_b32 s69, s59, s2
    s_xor_b32 s70, s60, s2
    v_writelane_b32 v36, -1.0, 0
    s_mov_b32 s2, 0xbf320000
    v_writelane_b32 v36, s2, 1
    s_mov_b32 s2, 0xbf060000
    v_writelane_b32 v36, s2, 2
    s_mov_b32 s2, 0xbeca0000
    v_writelane_b32 v36, s2, 3
    s_mov_b32 s2, 0xbe920000
    v_writelane_b32 v36, s2, 4
    s_mov_b32 s2, 0xbe3d0000
    v_writelane_b32 v36, s2, 5
    s_mov_b32 s2, 0xbdba0000
    v_writelane_b32 v36, s2, 6
    v_writelane_b32 v36, 0, 7
    s_mov_b32 s2, 0x3da30000
    v_writelane_b32 v36, s2, 8
    s_mov_b32 s2, 0x3e250000
    v_writelane_b32 v36, s2, 9
    s_mov_b32 s2, 0x3e7c0000
    v_writelane_b32 v36, s2, 10
    s_mov_b32 s2, 0x3ead0000
    v_writelane_b32 v36, s2, 11
    s_mov_b32 s2, 0x3ee20000
    v_writelane_b32 v36, s2, 12
    s_mov_b32 s2, 0x3f100000
    v_writelane_b32 v36, s2, 13
    s_mov_b32 s2, 0x3f390000
    v_writelane_b32 v36, s2, 14
    v_writelane_b32 v36, 1.0, 15
    v_lshlrev_b32 v37, 2, v2
    v_lshrrev_b32 v38, 4, v0
    v_lshlrev_b32 v38, 2, v38
    ds_bpermute_b32 v40, v37, v36
    ds_bpermute_b32 v41, v38, v36
    v_mul_u32_u24 v39, 8, v0
    v_add_u32 v39, 147456, v39
    v_and_b32 v15, 0, v0
    v_lshlrev_b32 v15, 3, v15
    v_add_u32 v15, 147456, v15
    v_lshlrev_b32 v16, 4, v1
    v_lshl_add_u32 v16, s3, 12, v16
    v_xor_b32 v17, 0x2000, v16
    v_add_u32 v16, 98304, v16
    v_add_u32 v17, 98304, v17
    v_mul_u32_u24 v3, 36864, v3
    v_add_u32 v18, v18, v3
    v_add_u32 v19, 9216, v18
    v_add_u32 v20, 18432, v18
    v_add_u32 v21, 27648, v18
    s_waitcnt lgkmcnt(0)
    ds_write_b64 v39, v[40:41]
    v_lshlrev_b32 v1, 3, v1
    v_lshl_add_u32 v1, s3, 11, v1
    v_xor_b32 v2, 4096, v1
    v_add_u32 v1, 147456, v1
    v_add_u32 v2, 147456, v2
    s_waitcnt lgkmcnt(0)
    s_barrier
    tbuffer_load_format_d16_xyzw v[144:145], v4, s[20:23], s44 format:[BUF_DATA_FORMAT_32_32_32_32,BUF_NUM_FORMAT_UINT] offen
    tbuffer_load_format_d16_xyzw v[148:149], v4, s[20:23], s45 format:[BUF_DATA_FORMAT_32_32_32_32,BUF_NUM_FORMAT_UINT] offen
    tbuffer_load_format_d16_xyzw v[152:153], v4, s[20:23], s46 format:[BUF_DATA_FORMAT_32_32_32_32,BUF_NUM_FORMAT_UINT] offen
    tbuffer_load_format_d16_xyzw v[156:157], v4, s[20:23], s47 format:[BUF_DATA_FORMAT_32_32_32_32,BUF_NUM_FORMAT_UINT] offen
    tbuffer_load_format_d16_xyzw v[146:147], v4, s[20:23], s48 format:[BUF_DATA_FORMAT_32_32_32_32,BUF_NUM_FORMAT_UINT] offen
    tbuffer_load_format_d16_xyzw v[150:151], v4, s[20:23], s49 format:[BUF_DATA_FORMAT_32_32_32_32,BUF_NUM_FORMAT_UINT] offen
    s_mov_b64 exec, 0
    s_cmp_eq_u32 s3, 0
    s_cbranch_scc1 L_pg0_standalone__normalfloat_lut_nf4__prompt_kernel
    s_cmp_eq_u32 s3, 1
    s_cbranch_scc1 L_pg1_standalone__normalfloat_lut_nf4__prompt_kernel
    s_cmp_eq_u32 s3, 2
    s_cbranch_scc1 L_pg2_standalone__normalfloat_lut_nf4__prompt_kernel
    s_cmp_eq_u32 s3, 3
    s_cbranch_scc1 L_pg3_standalone__normalfloat_lut_nf4__prompt_kernel
L_ret_standalone__normalfloat_lut_nf4__prompt_kernel:
    s_mov_b64 exec, -1
    s_waitcnt vmcnt(10)
    v_lshlrev_b32 v24, 16, v64
    v_and_b32 v25, 0xffff0000, v64
    v_lshlrev_b32 v26, 16, v65
    v_and_b32 v27, 0xffff0000, v65
    v_lshlrev_b32 v28, 16, v66
    v_and_b32 v29, 0xffff0000, v66
    v_lshlrev_b32 v30, 16, v67
    v_and_b32 v31, 0xffff0000, v67
    v_dot2_u32_u16 v128, v128, s74, v15
    v_dot2_u32_u16 v129, v129, s74, v15
    v_dot2_u32_u16 v132, v132, s74, v15
    v_dot2_u32_u16 v133, v133, s74, v15
    v_dot2_u32_u16 v136, v136, s74, v15
    v_dot2_u32_u16 v137, v137, s74, v15
    v_dot2_u32_u16 v140, v140, s74, v15
    v_dot2_u32_u16 v141, v141, s74, v15
    ds_read_b64 v[32:33], v128
    ds_read_b64 v[34:35], v129
    ds_read_b64 v[36:37], v132
    ds_read_b64 v[38:39], v133
    ds_read_b64 v[40:41], v136
    ds_read_b64 v[42:43], v137
    ds_read_b64 v[44:45], v140
    tbuffer_load_format_d16_xyzw v[154:155], v4, s[20:23], s50 format:[BUF_DATA_FORMAT_32_32_32_32,BUF_NUM_FORMAT_UINT] offen
    ds_read_b64 v[46:47], v141
    tbuffer_load_format_d16_xyzw v[158:159], v4, s[20:23], s51 format:[BUF_DATA_FORMAT_32_32_32_32,BUF_NUM_FORMAT_UINT] offen
    s_mov_b32 m0, s72
    s_nop 0
    buffer_load_dwordx4 v5, s[8:11], s61 offen lds
    s_add_u32 m0, m0, 0x1000
    s_nop 0
    buffer_load_dwordx4 v5, s[4:7], s52 offen lds
    s_waitcnt vmcnt(10) lgkmcnt(0)
    v_pk_mul_f32 v[32:33], v[32:33], v[24:25]
    v_pk_mul_f32 v[34:35], v[34:35], v[26:27]
    v_pk_mul_f32 v[36:37], v[36:37], v[24:25]
    v_pk_mul_f32 v[38:39], v[38:39], v[26:27]
    v_pk_mul_f32 v[40:41], v[40:41], v[24:25]
    v_pk_mul_f32 v[42:43], v[42:43], v[26:27]
    v_pk_mul_f32 v[44:45], v[44:45], v[24:25]
    v_pk_mul_f32 v[46:47], v[46:47], v[26:27]
    v_dot2_u32_u16 v130, v130, s74, v15
    v_dot2_u32_u16 v131, v131, s74, v15
    v_dot2_u32_u16 v134, v134, s74, v15
    v_dot2_u32_u16 v135, v135, s74, v15
    v_dot2_u32_u16 v138, v138, s74, v15
    v_dot2_u32_u16 v139, v139, s74, v15
    v_dot2_u32_u16 v142, v142, s74, v15
    v_dot2_u32_u16 v143, v143, s74, v15
    ds_read_b64 v[48:49], v130
    v_cvt_pk_bf16_f32 v128, v32, v36
    v_cvt_pk_bf16_f32 v129, v40, v44
    v_cvt_pk_bf16_f32 v132, v33, v37
    v_cvt_pk_bf16_f32 v133, v41, v45
    v_cvt_pk_bf16_f32 v136, v34, v38
    v_cvt_pk_bf16_f32 v137, v42, v46
    v_cvt_pk_bf16_f32 v140, v35, v39
    v_cvt_pk_bf16_f32 v141, v43, v47
    ds_read_b64 v[50:51], v131
    ds_read_b64 v[52:53], v134
    s_add_u32 m0, m0, 0x1000
    s_nop 0
    buffer_load_dwordx4 v5, s[4:7], s53 offen lds
    ds_read_b64 v[54:55], v135
    ds_read_b64 v[56:57], v138
    tbuffer_load_format_d16_xyzw v[160:161], v4, s[24:27], s36 format:[BUF_DATA_FORMAT_32_32_32_32,BUF_NUM_FORMAT_UINT] offen
    ds_read_b64 v[58:59], v139
    ds_read_b64 v[60:61], v142
    tbuffer_load_format_d16_xyzw v[164:165], v4, s[24:27], s37 format:[BUF_DATA_FORMAT_32_32_32_32,BUF_NUM_FORMAT_UINT] offen
    ds_read_b64 v[62:63], v143
    tbuffer_load_format_d16_xyzw v[168:169], v4, s[24:27], s38 format:[BUF_DATA_FORMAT_32_32_32_32,BUF_NUM_FORMAT_UINT] offen
    tbuffer_load_format_d16_xyzw v[172:173], v4, s[24:27], s39 format:[BUF_DATA_FORMAT_32_32_32_32,BUF_NUM_FORMAT_UINT] offen
    s_add_u32 m0, m0, s73
    s_nop 0
    buffer_load_dwordx4 v5, s[4:7], s54 offen lds
    s_waitcnt vmcnt(12) lgkmcnt(0)
    v_pk_mul_f32 v[48:49], v[48:49], v[24:25]
    v_pk_mul_f32 v[50:51], v[50:51], v[26:27]
    v_pk_mul_f32 v[52:53], v[52:53], v[24:25]
    v_pk_mul_f32 v[54:55], v[54:55], v[26:27]
    v_pk_mul_f32 v[56:57], v[56:57], v[24:25]
    v_pk_mul_f32 v[58:59], v[58:59], v[26:27]
    v_pk_mul_f32 v[60:61], v[60:61], v[24:25]
    v_pk_mul_f32 v[62:63], v[62:63], v[26:27]
    v_dot2_u32_u16 v144, v144, s74, v15
    v_dot2_u32_u16 v145, v145, s74, v15
    v_dot2_u32_u16 v148, v148, s74, v15
    v_dot2_u32_u16 v149, v149, s74, v15
    v_dot2_u32_u16 v152, v152, s74, v15
    v_dot2_u32_u16 v153, v153, s74, v15
    v_dot2_u32_u16 v156, v156, s74, v15
    v_dot2_u32_u16 v157, v157, s74, v15
    ds_read_b64 v[32:33], v144
    s_add_u32 m0, m0, 0x1000
    v_cvt_pk_bf16_f32 v130, v48, v52
    v_cvt_pk_bf16_f32 v131, v56, v60
    v_cvt_pk_bf16_f32 v134, v49, v53
    v_cvt_pk_bf16_f32 v135, v57, v61
    v_cvt_pk_bf16_f32 v138, v50, v54
    v_cvt_pk_bf16_f32 v139, v58, v62
    v_cvt_pk_bf16_f32 v142, v51, v55
    v_cvt_pk_bf16_f32 v143, v59, v63
    buffer_load_dwordx4 v5, s[4:7], s55 offen lds
    ds_read_b64 v[34:35], v145
    ds_read_b64 v[36:37], v148
    s_add_u32 m0, m0, 0x1000
    s_nop 0
    buffer_load_dwordx4 v5, s[4:7], s56 offen lds
    ds_read_b64 v[38:39], v149
    ds_read_b64 v[40:41], v152
    tbuffer_load_format_d16_xyzw v[162:163], v4, s[24:27], s40 format:[BUF_DATA_FORMAT_32_32_32_32,BUF_NUM_FORMAT_UINT] offen
    ds_read_b64 v[42:43], v153
    tbuffer_load_format_d16_xyzw v[166:167], v4, s[24:27], s41 format:[BUF_DATA_FORMAT_32_32_32_32,BUF_NUM_FORMAT_UINT] offen
    ds_read_b64 v[44:45], v156
    ds_read_b64 v[46:47], v157
    tbuffer_load_format_d16_xyzw v[170:171], v4, s[24:27], s42 format:[BUF_DATA_FORMAT_32_32_32_32,BUF_NUM_FORMAT_UINT] offen
    tbuffer_load_format_d16_xyzw v[174:175], v4, s[24:27], s43 format:[BUF_DATA_FORMAT_32_32_32_32,BUF_NUM_FORMAT_UINT] offen
    s_add_u32 m0, m0, s73
    s_nop 0
    buffer_load_dwordx4 v5, s[4:7], s57 offen lds
    s_add_u32 m0, m0, s73
    s_waitcnt vmcnt(15) lgkmcnt(0)
    v_pk_mul_f32 v[32:33], v[32:33], v[24:25]
    v_pk_mul_f32 v[34:35], v[34:35], v[26:27]
    v_pk_mul_f32 v[36:37], v[36:37], v[24:25]
    v_pk_mul_f32 v[38:39], v[38:39], v[26:27]
    v_pk_mul_f32 v[40:41], v[40:41], v[24:25]
    v_pk_mul_f32 v[42:43], v[42:43], v[26:27]
    v_pk_mul_f32 v[44:45], v[44:45], v[24:25]
    v_pk_mul_f32 v[46:47], v[46:47], v[26:27]
    v_dot2_u32_u16 v146, v146, s74, v15
    v_dot2_u32_u16 v147, v147, s74, v15
    v_dot2_u32_u16 v150, v150, s74, v15
    v_dot2_u32_u16 v151, v151, s74, v15
    v_dot2_u32_u16 v154, v154, s74, v15
    v_dot2_u32_u16 v155, v155, s74, v15
    v_dot2_u32_u16 v158, v158, s74, v15
    v_dot2_u32_u16 v159, v159, s74, v15
    buffer_load_dwordx4 v5, s[4:7], s58 offen lds
    v_cvt_pk_bf16_f32 v144, v32, v36
    v_cvt_pk_bf16_f32 v145, v40, v44
    v_cvt_pk_bf16_f32 v148, v33, v37
    v_cvt_pk_bf16_f32 v149, v41, v45
    v_cvt_pk_bf16_f32 v152, v34, v38
    v_cvt_pk_bf16_f32 v153, v42, v46
    v_cvt_pk_bf16_f32 v156, v35, v39
    v_cvt_pk_bf16_f32 v157, v43, v47
    ds_read_b64 v[48:49], v146
    ds_read_b64 v[50:51], v147
    s_add_u32 m0, m0, s73
    s_nop 0
    buffer_load_dwordx4 v5, s[4:7], s59 offen lds
    ds_read_b64 v[52:53], v150
    ds_read_b64 v[54:55], v151
    tbuffer_load_format_d16_xyzw v[176:177], v4, s[24:27], s44 format:[BUF_DATA_FORMAT_32_32_32_32,BUF_NUM_FORMAT_UINT] offen
    ds_read_b64 v[56:57], v154
    ds_read_b64 v[58:59], v155
    tbuffer_load_format_d16_xyzw v[180:181], v4, s[24:27], s45 format:[BUF_DATA_FORMAT_32_32_32_32,BUF_NUM_FORMAT_UINT] offen
    s_waitcnt vmcnt(16)
    s_barrier
    ds_read_b64 v[60:61], v158
    tbuffer_load_format_d16_xyzw v[184:185], v4, s[24:27], s46 format:[BUF_DATA_FORMAT_32_32_32_32,BUF_NUM_FORMAT_UINT] offen
    ds_read_b64 v[62:63], v159
    v_xor_b32 v13, s75, v9
    ds_read_b128 a[160:163], v13 offset:0
    tbuffer_load_format_d16_xyzw v[188:189], v4, s[24:27], s47 format:[BUF_DATA_FORMAT_32_32_32_32,BUF_NUM_FORMAT_UINT] offen
    v_xor_b32 v14, s75, v10
    ds_read_b128 a[164:167], v14 offset:0
    s_add_u32 m0, m0, s73
    s_nop 0
    buffer_load_dwordx4 v5, s[4:7], s60 offen lds
    s_add_u32 m0, m0, s73
    s_nop 0
    buffer_load_dwordx4 v5, s[4:7], s62 offen lds
    s_waitcnt vmcnt(16) lgkmcnt(2)
    v_pk_mul_f32 v[48:49], v[48:49], v[24:25]
    v_pk_mul_f32 v[50:51], v[50:51], v[26:27]
    v_pk_mul_f32 v[52:53], v[52:53], v[24:25]
    v_pk_mul_f32 v[54:55], v[54:55], v[26:27]
    v_pk_mul_f32 v[56:57], v[56:57], v[24:25]
    v_pk_mul_f32 v[58:59], v[58:59], v[26:27]
    v_pk_mul_f32 v[60:61], v[60:61], v[24:25]
    v_pk_mul_f32 v[62:63], v[62:63], v[26:27]
    v_dot2_u32_u16 v160, v160, s74, v15
    v_dot2_u32_u16 v161, v161, s74, v15
    v_dot2_u32_u16 v164, v164, s74, v15
    v_dot2_u32_u16 v165, v165, s74, v15
    v_dot2_u32_u16 v168, v168, s74, v15
    v_dot2_u32_u16 v169, v169, s74, v15
    v_dot2_u32_u16 v172, v172, s74, v15
    v_dot2_u32_u16 v173, v173, s74, v15
    s_branch L_pg0_standalone__normalfloat_lut_nf4__prompt_kernel
L_pf0_standalone__normalfloat_lut_nf4__prompt_kernel:
    s_cmp_ge_u32 s2, 256
    s_cbranch_scc1 L_end_standalone__normalfloat_lut_nf4__prompt_kernel
    v_lshrrev_b32 v2, 6, v0
    v_and_b32 v1, 63, v0
    s_sub_u32 s2, s2, 252
    v_readfirstlane_b32 s3, v2
    v_lshrrev_b32 v2, 2, v1
    v_lshlrev_b32 v2, 3, v2
    v_and_or_b32 v2, v1, 3, v2
    v_lshlrev_b32 v4, 7, v2
    v_lshrrev_b32 v2, 1, v1
    v_lshlrev_b32 v2, 3, v2
    v_and_or_b32 v2, v1, 1, v2
    v_lshrrev_b32 v3, 5, v1
    v_lshl_add_u32 v2, v3, 2, v2
    v_add_u32 v2, 2, v2
    v_lshlrev_b32 v5, 7, v2
    s_lshl_b32 s3, s3, 2
    s_add_u32 s12, s3, s2
    s_waitcnt lgkmcnt(0)
    s_mov_b32 s6, 2097152
    s_mov_b32 s7, 0x20000
L_pf1_standalone__normalfloat_lut_nf4__prompt_kernel:
    s_sub_u32 s13, s12, 14
    s_cmp_lt_u32 s13, 0
    s_cselect_b32 s18, 1, 0
    s_sub_u32 s14, s12, 0
    s_cmp_lt_u32 s12, 14
    s_cselect_b32 s14, s12, s14
    s_cmp_eq_u32 s18, 1
    s_cselect_b32 s13, s13, s14
    s_mul_i32 s14, s13, 9363
    s_lshr_b32 s14, s14, 16
    s_mul_i32 s15, s14, 7
    s_sub_u32 s15, s13, s15
    s_mul_i32 s16, s15, 18
    s_min_u32 s15, s15, 2
    s_add_u32 s16, s16, s15
    s_lshl_b32 s17, s14, s18
    s_add_u32 s16, s16, s17
    s_lshl_b32 s16, s16, 14
    s_cmp_eq_u32 s18, 1
    s_cbranch_scc1 L_pf2_standalone__normalfloat_lut_nf4__prompt_kernel
    s_andn2_b32 s14, 1, s14
    s_lshl_b32 s14, s14, 9
    s_add_u32 s16, s16, s14
    buffer_load_dword v6, v4, s[4:7], s16 offen
    s_branch L_pf3_standalone__normalfloat_lut_nf4__prompt_kernel
L_pf2_standalone__normalfloat_lut_nf4__prompt_kernel:
    buffer_load_dword v6, v5, s[4:7], s16 offen
L_pf3_standalone__normalfloat_lut_nf4__prompt_kernel:
    s_add_u32 s12, s12, 16
    s_cmp_lt_u32 s12, 126
    s_cbranch_scc1 L_pf1_standalone__normalfloat_lut_nf4__prompt_kernel
    s_waitcnt vmcnt(0)
    s_endpgm
.p2align 12
L_pg0_standalone__normalfloat_lut_nf4__prompt_kernel:
.if (L_pg0_standalone__normalfloat_lut_nf4__prompt_kernel-L_pg0_standalone__normalfloat_lut_nf4__prompt_kernel) != 0
.error "size model"
.endif
    s_cbranch_execz L_ret_standalone__normalfloat_lut_nf4__prompt_kernel
    ds_read_b128 a[168:171], v9 offset:4096
    v_cvt_pk_bf16_f32 v146, v48, v52
    v_cvt_pk_bf16_f32 v147, v56, v60
    v_cvt_pk_bf16_f32 v150, v49, v53
    v_cvt_pk_bf16_f32 v151, v57, v61
    v_cvt_pk_bf16_f32 v154, v50, v54
    v_cvt_pk_bf16_f32 v155, v58, v62
    v_cvt_pk_bf16_f32 v158, v51, v55
    v_cvt_pk_bf16_f32 v159, v59, v63
    ds_read_b64 v[32:33], v160
    s_add_u32 m0, m0, s73
    s_nop 0
    buffer_load_dwordx4 v6, s[8:11], s61 offen lds
    ds_read_b64 v[34:35], v161
    ds_read_b64 v[36:37], v164
    tbuffer_load_format_d16_xyzw v[178:179], v4, s[24:27], s48 format:[BUF_DATA_FORMAT_32_32_32_32,BUF_NUM_FORMAT_UINT] offen
    ds_read_b64 v[38:39], v165
    ds_read_b128 a[172:175], v10 offset:4096
    s_waitcnt lgkmcnt(6)
    v_mfma_f32_16x16x32_bf16 a[144:147], a[160:163], v[128:131], 0
    ds_read_b64 v[40:41], v168
    v_mfma_f32_16x16x32_bf16 a[144:147], a[164:167], v[144:147], a[144:147]
    tbuffer_load_format_d16_xyzw v[182:183], v4, s[24:27], s49 format:[BUF_DATA_FORMAT_32_32_32_32,BUF_NUM_FORMAT_UINT] offen
    v_mfma_f32_16x16x32_bf16 a[148:151], a[164:167], v[148:151], 0
    ds_read_b128 a[176:179], v9 offset:8192
    v_mfma_f32_16x16x32_bf16 a[148:151], a[160:163], v[132:135], a[148:151]
    ds_read_b64 v[42:43], v169
    v_mfma_f32_16x16x32_bf16 a[152:155], a[160:163], v[136:139], 0
    tbuffer_load_format_d16_xyzw v[186:187], v4, s[24:27], s50 format:[BUF_DATA_FORMAT_32_32_32_32,BUF_NUM_FORMAT_UINT] offen
    v_mfma_f32_16x16x32_bf16 a[152:155], a[164:167], v[152:155], a[152:155]
    ds_read_b64 v[44:45], v172
    v_mfma_f32_16x16x32_bf16 a[156:159], a[164:167], v[156:159], 0
    ds_read_b64 v[46:47], v173
    s_waitcnt vmcnt(17)
    s_barrier
    v_mfma_f32_16x16x32_bf16 a[156:159], a[160:163], v[140:143], a[156:159]
    ds_read_b128 a[180:183], v10 offset:8192
    s_waitcnt lgkmcnt(6)
    v_mfma_f32_16x16x32_bf16 a[0:3], a[168:171], v[128:131], 0
    tbuffer_load_format_d16_xyzw v[190:191], v4, s[24:27], s51 format:[BUF_DATA_FORMAT_32_32_32_32,BUF_NUM_FORMAT_UINT] offen
    v_mfma_f32_16x16x32_bf16 a[0:3], a[172:175], v[144:147], a[0:3]
    ds_read_b128 a[184:187], v9 offset:12288
    s_add_u32 m0, m0, s73
    v_mfma_f32_16x16x32_bf16 a[4:7], a[172:175], v[148:151], 0
    buffer_load_dwordx4 v6, s[4:7], s52 offen lds
    v_mfma_f32_16x16x32_bf16 a[4:7], a[168:171], v[132:135], a[4:7]
    v_mfma_f32_16x16x32_bf16 a[8:11], a[168:171], v[136:139], 0
    ds_read_b128 a[160:163], v10 offset:12288
    s_add_u32 m0, m0, 0x1000
    v_mfma_f32_16x16x32_bf16 a[8:11], a[172:175], v[152:155], a[8:11]
    buffer_load_dwordx4 v6, s[4:7], s53 offen lds
    v_mfma_f32_16x16x32_bf16 a[12:15], a[172:175], v[156:159], 0
    s_add_u32 m0, m0, 0x1000
    s_nop 0
    s_waitcnt vmcnt(16) lgkmcnt(3)
    v_pk_mul_f32 v[32:33], v[32:33], v[24:25]
    v_pk_mul_f32 v[34:35], v[34:35], v[26:27]
    v_pk_mul_f32 v[36:37], v[36:37], v[24:25]
    v_pk_mul_f32 v[38:39], v[38:39], v[26:27]
    v_pk_mul_f32 v[40:41], v[40:41], v[24:25]
    v_pk_mul_f32 v[42:43], v[42:43], v[26:27]
    v_pk_mul_f32 v[44:45], v[44:45], v[24:25]
    v_pk_mul_f32 v[46:47], v[46:47], v[26:27]
    v_dot2_u32_u16 v162, v162, s74, v15
    v_dot2_u32_u16 v163, v163, s74, v15
    v_dot2_u32_u16 v166, v166, s74, v15
    v_dot2_u32_u16 v167, v167, s74, v15
    v_dot2_u32_u16 v170, v170, s74, v15
    v_dot2_u32_u16 v171, v171, s74, v15
    v_dot2_u32_u16 v174, v174, s74, v15
    v_dot2_u32_u16 v175, v175, s74, v15
    v_mfma_f32_16x16x32_bf16 a[12:15], a[168:171], v[140:143], a[12:15]
    ds_read_b64 v[48:49], v162
    s_waitcnt lgkmcnt(3)
    v_mfma_f32_16x16x32_bf16 a[16:19], a[176:179], v[128:131], 0
    buffer_load_dwordx4 v6, s[4:7], s54 offen lds
    v_mfma_f32_16x16x32_bf16 a[16:19], a[180:183], v[144:147], a[16:19]
    ds_read_b64 v[50:51], v163
    v_cvt_pk_bf16_f32 v160, v32, v36
    v_mfma_f32_16x16x32_bf16 a[20:23], a[180:183], v[148:151], 0
    ds_read_b128 a[164:167], v9 offset:16384
    v_cvt_pk_bf16_f32 v161, v40, v44
    v_mfma_f32_16x16x32_bf16 a[20:23], a[176:179], v[132:135], a[20:23]
    tbuffer_load_format_d16_xyzw v[192:193], v4, s[28:31], s36 format:[BUF_DATA_FORMAT_32_32_32_32,BUF_NUM_FORMAT_UINT] offen
    v_mfma_f32_16x16x32_bf16 a[24:27], a[176:179], v[136:139], 0
    ds_read_b64 v[52:53], v166
    v_cvt_pk_bf16_f32 v164, v33, v37
    v_mfma_f32_16x16x32_bf16 a[24:27], a[180:183], v[152:155], a[24:27]
    ds_read_b64 v[54:55], v167
    v_cvt_pk_bf16_f32 v165, v41, v45
    v_mfma_f32_16x16x32_bf16 a[28:31], a[180:183], v[156:159], 0
    tbuffer_load_format_d16_xyzw v[196:197], v4, s[28:31], s37 format:[BUF_DATA_FORMAT_32_32_32_32,BUF_NUM_FORMAT_UINT] offen
    v_mfma_f32_16x16x32_bf16 a[28:31], a[176:179], v[140:143], a[28:31]
    ds_read_b128 a[168:171], v10 offset:16384
    s_waitcnt lgkmcnt(6)
    v_mfma_f32_16x16x32_bf16 a[32:35], a[184:187], v[128:131], 0
    ds_read_b64 v[56:57], v170
    v_cvt_pk_bf16_f32 v168, v34, v38
    v_mfma_f32_16x16x32_bf16 a[32:35], a[160:163], v[144:147], a[32:35]
    tbuffer_load_format_d16_xyzw v[200:201], v4, s[28:31], s38 format:[BUF_DATA_FORMAT_32_32_32_32,BUF_NUM_FORMAT_UINT] offen
    v_mfma_f32_16x16x32_bf16 a[36:39], a[160:163], v[148:151], 0
    ds_read_b64 v[58:59], v171
    v_cvt_pk_bf16_f32 v169, v42, v46
    v_mfma_f32_16x16x32_bf16 a[36:39], a[184:187], v[132:135], a[36:39]
    ds_read_b128 a[172:175], v9 offset:20480
    v_cvt_pk_bf16_f32 v172, v35, v39
    v_mfma_f32_16x16x32_bf16 a[40:43], a[184:187], v[136:139], 0
    tbuffer_load_format_d16_xyzw v[204:205], v4, s[28:31], s39 format:[BUF_DATA_FORMAT_32_32_32_32,BUF_NUM_FORMAT_UINT] offen
    v_mfma_f32_16x16x32_bf16 a[40:43], a[160:163], v[152:155], a[40:43]
    ds_read_b64 v[60:61], v174
    v_cvt_pk_bf16_f32 v173, v43, v47
    v_mfma_f32_16x16x32_bf16 a[44:47], a[160:163], v[156:159], 0
    s_waitcnt vmcnt(18)
    s_barrier
    v_mfma_f32_16x16x32_bf16 a[44:47], a[184:187], v[140:143], a[44:47]
    ds_read_b64 v[62:63], v175
    s_waitcnt lgkmcnt(5)
    v_mfma_f32_16x16x32_bf16 a[48:51], a[164:167], v[128:131], 0
    tbuffer_load_format_d16_xyzw v[194:195], v4, s[28:31], s40 format:[BUF_DATA_FORMAT_32_32_32_32,BUF_NUM_FORMAT_UINT] offen
    v_mfma_f32_16x16x32_bf16 a[48:51], a[168:171], v[144:147], a[48:51]
    ds_read_b128 a[176:179], v10 offset:20480
    v_mfma_f32_16x16x32_bf16 a[52:55], a[168:171], v[148:151], 0
    tbuffer_load_format_d16_xyzw v[198:199], v4, s[28:31], s41 format:[BUF_DATA_FORMAT_32_32_32_32,BUF_NUM_FORMAT_UINT] offen
    v_mfma_f32_16x16x32_bf16 a[52:55], a[164:167], v[132:135], a[52:55]
    ds_read_b128 a[180:183], v9 offset:24576
    v_mfma_f32_16x16x32_bf16 a[56:59], a[164:167], v[136:139], 0
    ds_read_b128 a[184:187], v10 offset:24576
    s_waitcnt vmcnt(16) lgkmcnt(3)
    v_pk_mul_f32 v[48:49], v[48:49], v[24:25]
    v_pk_mul_f32 v[50:51], v[50:51], v[26:27]
    v_pk_mul_f32 v[52:53], v[52:53], v[24:25]
    v_pk_mul_f32 v[54:55], v[54:55], v[26:27]
    v_pk_mul_f32 v[56:57], v[56:57], v[24:25]
    v_pk_mul_f32 v[58:59], v[58:59], v[26:27]
    v_pk_mul_f32 v[60:61], v[60:61], v[24:25]
    v_pk_mul_f32 v[62:63], v[62:63], v[26:27]
    v_dot2_u32_u16 v176, v176, s74, v15
    v_dot2_u32_u16 v177, v177, s74, v15
    v_dot2_u32_u16 v180, v180, s74, v15
    v_dot2_u32_u16 v181, v181, s74, v15
    v_dot2_u32_u16 v184, v184, s74, v15
    v_dot2_u32_u16 v185, v185, s74, v15
    v_dot2_u32_u16 v188, v188, s74, v15
    v_dot2_u32_u16 v189, v189, s74, v15
    v_mfma_f32_16x16x32_bf16 a[56:59], a[168:171], v[152:155], a[56:59]
    tbuffer_load_format_d16_xyzw v[202:203], v4, s[28:31], s42 format:[BUF_DATA_FORMAT_32_32_32_32,BUF_NUM_FORMAT_UINT] offen
    v_mfma_f32_16x16x32_bf16 a[60:63], a[168:171], v[156:159], 0
    ds_read_b64 v[32:33], v176
    v_cvt_pk_bf16_f32 v162, v48, v52
    v_mfma_f32_16x16x32_bf16 a[60:63], a[164:167], v[140:143], a[60:63]
    ds_read_b64 v[34:35], v177
    s_waitcnt lgkmcnt(4)
    v_mfma_f32_16x16x32_bf16 a[64:67], a[172:175], v[128:131], 0
    tbuffer_load_format_d16_xyzw v[206:207], v4, s[28:31], s43 format:[BUF_DATA_FORMAT_32_32_32_32,BUF_NUM_FORMAT_UINT] offen
    v_mfma_f32_16x16x32_bf16 a[64:67], a[176:179], v[144:147], a[64:67]
    ds_read_b64 v[36:37], v180
    v_cvt_pk_bf16_f32 v163, v56, v60
    v_mfma_f32_16x16x32_bf16 a[68:71], a[176:179], v[148:151], 0
    ds_read_b128 a[160:163], v9 offset:28672
    v_cvt_pk_bf16_f32 v166, v49, v53
    v_mfma_f32_16x16x32_bf16 a[68:71], a[172:175], v[132:135], a[68:71]
    ds_read_b64 v[38:39], v181
    v_cvt_pk_bf16_f32 v167, v57, v61
    v_mfma_f32_16x16x32_bf16 a[72:75], a[172:175], v[136:139], 0
    ds_read_b64 v[40:41], v184
    v_cvt_pk_bf16_f32 v170, v50, v54
    v_mfma_f32_16x16x32_bf16 a[72:75], a[176:179], v[152:155], a[72:75]
    ds_read_b128 a[164:167], v10 offset:28672
    v_cvt_pk_bf16_f32 v171, v58, v62
    v_mfma_f32_16x16x32_bf16 a[76:79], a[176:179], v[156:159], 0
    ds_read_b64 v[42:43], v185
    v_cvt_pk_bf16_f32 v174, v51, v55
    v_mfma_f32_16x16x32_bf16 a[76:79], a[172:175], v[140:143], a[76:79]
    ds_read_b64 v[44:45], v188
    s_waitcnt lgkmcnt(9)
    v_mfma_f32_16x16x32_bf16 a[80:83], a[180:183], v[128:131], 0
    v_cvt_pk_bf16_f32 v175, v59, v63
    v_mfma_f32_16x16x32_bf16 a[80:83], a[184:187], v[144:147], a[80:83]
    ds_read_b128 a[168:171], v9 offset:32768
    v_mfma_f32_16x16x32_bf16 a[84:87], a[184:187], v[148:151], 0
    ds_read_b64 v[46:47], v189
    v_mfma_f32_16x16x32_bf16 a[84:87], a[180:183], v[132:135], a[84:87]
    v_mfma_f32_16x16x32_bf16 a[88:91], a[180:183], v[136:139], 0
    v_mfma_f32_16x16x32_bf16 a[88:91], a[184:187], v[152:155], a[88:91]
    ds_read_b128 a[172:175], v10 offset:32768
    v_mfma_f32_16x16x32_bf16 a[92:95], a[184:187], v[156:159], 0
    s_waitcnt vmcnt(15)
    s_barrier
    v_mfma_f32_16x16x32_bf16 a[92:95], a[180:183], v[140:143], a[92:95]
    s_waitcnt lgkmcnt(5)
    v_mfma_f32_16x16x32_bf16 a[96:99], a[160:163], v[128:131], 0
    v_mfma_f32_16x16x32_bf16 a[96:99], a[164:167], v[144:147], a[96:99]
    ds_read_b128 a[176:179], v9 offset:36864
    v_mfma_f32_16x16x32_bf16 a[100:103], a[164:167], v[148:151], 0
    s_waitcnt vmcnt(11) lgkmcnt(2)
    v_pk_mul_f32 v[32:33], v[32:33], v[24:25]
    v_pk_mul_f32 v[34:35], v[34:35], v[26:27]
    v_pk_mul_f32 v[36:37], v[36:37], v[24:25]
    v_pk_mul_f32 v[38:39], v[38:39], v[26:27]
    v_pk_mul_f32 v[40:41], v[40:41], v[24:25]
    v_pk_mul_f32 v[42:43], v[42:43], v[26:27]
    v_pk_mul_f32 v[44:45], v[44:45], v[24:25]
    v_pk_mul_f32 v[46:47], v[46:47], v[26:27]
    v_dot2_u32_u16 v178, v178, s74, v15
    v_dot2_u32_u16 v179, v179, s74, v15
    v_dot2_u32_u16 v182, v182, s74, v15
    v_dot2_u32_u16 v183, v183, s74, v15
    v_dot2_u32_u16 v186, v186, s74, v15
    v_dot2_u32_u16 v187, v187, s74, v15
    v_dot2_u32_u16 v190, v190, s74, v15
    v_dot2_u32_u16 v191, v191, s74, v15
    v_mfma_f32_16x16x32_bf16 a[100:103], a[160:163], v[132:135], a[100:103]
    ds_read_b64 v[48:49], v178
    s_add_u32 m0, m0, 0x1000
    v_mfma_f32_16x16x32_bf16 a[104:107], a[160:163], v[136:139], 0
    buffer_load_dwordx4 v6, s[4:7], s55 offen lds
    v_mfma_f32_16x16x32_bf16 a[104:107], a[164:167], v[152:155], a[104:107]
    ds_read_b64 v[50:51], v179
    s_add_u32 m0, m0, 0x1000
    v_mfma_f32_16x16x32_bf16 a[108:111], a[164:167], v[156:159], 0
    buffer_load_dwordx4 v6, s[4:7], s56 offen lds
    v_mfma_f32_16x16x32_bf16 a[108:111], a[160:163], v[140:143], a[108:111]
    ds_read_b128 a[180:183], v10 offset:36864
    s_waitcnt lgkmcnt(4)
    v_mfma_f32_16x16x32_bf16 a[112:115], a[168:171], v[128:131], 0
    ds_read_b64 v[52:53], v182
    v_cvt_pk_bf16_f32 v176, v32, v36
    v_mfma_f32_16x16x32_bf16 a[112:115], a[172:175], v[144:147], a[112:115]
    ds_read_b64 v[54:55], v183
    s_add_u32 m0, m0, s73
    v_mfma_f32_16x16x32_bf16 a[116:119], a[172:175], v[148:151], 0
    buffer_load_dwordx4 v6, s[4:7], s57 offen lds
    v_mfma_f32_16x16x32_bf16 a[116:119], a[168:171], v[132:135], a[116:119]
    ds_read_b128 a[184:187], v9 offset:40960
    v_cvt_pk_bf16_f32 v177, v40, v44
    v_mfma_f32_16x16x32_bf16 a[120:123], a[168:171], v[136:139], 0
    ds_read_b64 v[56:57], v186
    v_cvt_pk_bf16_f32 v180, v33, v37
    v_mfma_f32_16x16x32_bf16 a[120:123], a[172:175], v[152:155], a[120:123]
    ds_read_b64 v[58:59], v187
    v_cvt_pk_bf16_f32 v181, v41, v45
    v_mfma_f32_16x16x32_bf16 a[124:127], a[172:175], v[156:159], 0
    tbuffer_load_format_d16_xyzw v[208:209], v4, s[28:31], s44 format:[BUF_DATA_FORMAT_32_32_32_32,BUF_NUM_FORMAT_UINT] offen
    v_mfma_f32_16x16x32_bf16 a[124:127], a[168:171], v[140:143], a[124:127]
    ds_read_b128 a[160:163], v10 offset:40960
    s_waitcnt lgkmcnt(6)
    v_mfma_f32_16x16x32_bf16 a[128:131], a[176:179], v[128:131], 0
    ds_read_b64 v[60:61], v190
    v_cvt_pk_bf16_f32 v184, v34, v38
    v_mfma_f32_16x16x32_bf16 a[128:131], a[180:183], v[144:147], a[128:131]
    tbuffer_load_format_d16_xyzw v[212:213], v4, s[28:31], s45 format:[BUF_DATA_FORMAT_32_32_32_32,BUF_NUM_FORMAT_UINT] offen
    v_mfma_f32_16x16x32_bf16 a[132:135], a[180:183], v[148:151], 0
    ds_read_b64 v[62:63], v191
    v_xor_b32 v13, s75, v9
    v_mfma_f32_16x16x32_bf16 a[132:135], a[176:179], v[132:135], a[132:135]
    ds_read_b128 a[164:167], v13 offset:45056
    v_cvt_pk_bf16_f32 v185, v42, v46
    v_mfma_f32_16x16x32_bf16 a[136:139], a[176:179], v[136:139], 0
    v_xor_b32 v14, s75, v10
    v_cvt_pk_bf16_f32 v188, v35, v39
    v_mfma_f32_16x16x32_bf16 a[136:139], a[180:183], v[152:155], a[136:139]
    ds_read_b128 a[168:171], v14 offset:45056
    v_cvt_pk_bf16_f32 v189, v43, v47
    v_mfma_f32_16x16x32_bf16 a[140:143], a[180:183], v[156:159], 0
    s_waitcnt vmcnt(13)
    s_barrier
    v_mfma_f32_16x16x32_bf16 a[140:143], a[176:179], v[140:143], a[140:143]
    s_add_u32 m0, m0, s73
    s_waitcnt lgkmcnt(4)
    v_mfma_f32_16x16x32_bf16 v[64:67], a[184:187], v[128:131], 0
    ds_read_b128 a[172:175], v9 offset:49152
    s_waitcnt vmcnt(9) lgkmcnt(3)
    v_pk_mul_f32 v[48:49], v[48:49], v[24:25]
    v_pk_mul_f32 v[50:51], v[50:51], v[26:27]
    v_pk_mul_f32 v[52:53], v[52:53], v[24:25]
    v_pk_mul_f32 v[54:55], v[54:55], v[26:27]
    v_pk_mul_f32 v[56:57], v[56:57], v[24:25]
    v_pk_mul_f32 v[58:59], v[58:59], v[26:27]
    v_pk_mul_f32 v[60:61], v[60:61], v[24:25]
    v_pk_mul_f32 v[62:63], v[62:63], v[26:27]
    v_dot2_u32_u16 v192, v192, s74, v15
    v_dot2_u32_u16 v193, v193, s74, v15
    v_dot2_u32_u16 v196, v196, s74, v15
    v_dot2_u32_u16 v197, v197, s74, v15
    v_dot2_u32_u16 v200, v200, s74, v15
    v_dot2_u32_u16 v201, v201, s74, v15
    v_dot2_u32_u16 v204, v204, s74, v15
    v_dot2_u32_u16 v205, v205, s74, v15
    v_mfma_f32_16x16x32_bf16 v[64:67], a[160:163], v[144:147], v[64:67]
    tbuffer_load_format_d16_xyzw v[216:217], v4, s[28:31], s46 format:[BUF_DATA_FORMAT_32_32_32_32,BUF_NUM_FORMAT_UINT] offen
    v_cvt_pk_bf16_f32 v183, v57, v61
    v_cvt_pk_bf16_f32 v186, v50, v54
    v_cvt_pk_bf16_f32 v187, v58, v62
    v_cvt_pk_bf16_f32 v190, v51, v55
    v_cvt_pk_bf16_f32 v191, v59, v63
    v_mfma_f32_16x16x32_bf16 v[68:71], a[160:163], v[148:151], 0
    tbuffer_load_format_d16_xyzw v[220:221], v4, s[28:31], s47 format:[BUF_DATA_FORMAT_32_32_32_32,BUF_NUM_FORMAT_UINT] offen
    v_mfma_f32_16x16x32_bf16 v[68:71], a[184:187], v[132:135], v[68:71]
    ds_read_b64 v[32:33], v192
    v_cvt_pk_bf16_f32 v178, v48, v52
    v_mfma_f32_16x16x32_bf16 v[72:75], a[184:187], v[136:139], 0
    ds_read_b64 v[34:35], v193
    v_cvt_pk_bf16_f32 v179, v56, v60
    v_mfma_f32_16x16x32_bf16 v[72:75], a[160:163], v[152:155], v[72:75]
    buffer_load_dwordx4 v6, s[4:7], s58 offen lds
    v_mfma_f32_16x16x32_bf16 v[76:79], a[160:163], v[156:159], 0
    ds_read_b64 v[36:37], v196
    v_cvt_pk_bf16_f32 v182, v49, v53
    v_mfma_f32_16x16x32_bf16 v[76:79], a[184:187], v[140:143], v[76:79]
    ds_read_b128 a[176:179], v10 offset:49152
    s_add_u32 m0, m0, 0x1000
    s_waitcnt lgkmcnt(5)
    v_mfma_f32_16x16x32_bf16 a[144:147], a[164:167], v[160:163], a[144:147]
    buffer_load_dwordx4 v6, s[4:7], s59 offen lds
    v_mfma_f32_16x16x32_bf16 a[144:147], a[168:171], v[176:179], a[144:147]
    ds_read_b64 v[38:39], v197
    s_add_u32 m0, m0, s73
    v_mfma_f32_16x16x32_bf16 a[148:151], a[168:171], v[180:183], a[148:151]
    buffer_load_dwordx4 v6, s[4:7], s60 offen lds
    v_mfma_f32_16x16x32_bf16 a[148:151], a[164:167], v[164:167], a[148:151]
    ds_read_b64 v[40:41], v200
    v_mfma_f32_16x16x32_bf16 a[152:155], a[164:167], v[168:171], a[152:155]
    ds_read_b128 a[180:183], v9 offset:53248
    v_mfma_f32_16x16x32_bf16 a[152:155], a[168:171], v[184:187], a[152:155]
    ds_read_b64 v[42:43], v201
    v_mfma_f32_16x16x32_bf16 a[156:159], a[168:171], v[188:191], a[156:159]
    tbuffer_load_format_d16_xyzw v[210:211], v4, s[28:31], s48 format:[BUF_DATA_FORMAT_32_32_32_32,BUF_NUM_FORMAT_UINT] offen
    v_mfma_f32_16x16x32_bf16 a[156:159], a[164:167], v[172:175], a[156:159]
    ds_read_b64 v[44:45], v204
    s_waitcnt lgkmcnt(5)
    v_mfma_f32_16x16x32_bf16 a[0:3], a[172:175], v[160:163], a[0:3]
    ds_read_b64 v[46:47], v205
    v_mfma_f32_16x16x32_bf16 a[0:3], a[176:179], v[176:179], a[0:3]
    tbuffer_load_format_d16_xyzw v[214:215], v4, s[28:31], s49 format:[BUF_DATA_FORMAT_32_32_32_32,BUF_NUM_FORMAT_UINT] offen
    v_mfma_f32_16x16x32_bf16 a[4:7], a[176:179], v[180:183], a[4:7]
    ds_read_b128 a[184:187], v10 offset:53248
    v_mfma_f32_16x16x32_bf16 a[4:7], a[172:175], v[164:167], a[4:7]
    ds_read_b128 a[160:163], v9 offset:57344
    v_mfma_f32_16x16x32_bf16 a[8:11], a[172:175], v[168:171], a[8:11]
    tbuffer_load_format_d16_xyzw v[218:219], v4, s[28:31], s50 format:[BUF_DATA_FORMAT_32_32_32_32,BUF_NUM_FORMAT_UINT] offen
    v_mfma_f32_16x16x32_bf16 a[8:11], a[176:179], v[184:187], a[8:11]
    ds_read_b128 a[164:167], v10 offset:57344
    s_waitcnt vmcnt(13) lgkmcnt(3)
    v_pk_mul_f32 v[32:33], v[32:33], v[28:29]
    v_pk_mul_f32 v[34:35], v[34:35], v[30:31]
    v_pk_mul_f32 v[36:37], v[36:37], v[28:29]
    v_pk_mul_f32 v[38:39], v[38:39], v[30:31]
    v_pk_mul_f32 v[40:41], v[40:41], v[28:29]
    v_pk_mul_f32 v[42:43], v[42:43], v[30:31]
    v_pk_mul_f32 v[44:45], v[44:45], v[28:29]
    v_pk_mul_f32 v[46:47], v[46:47], v[30:31]
    v_dot2_u32_u16 v194, v194, s74, v15
    v_dot2_u32_u16 v195, v195, s74, v15
    v_dot2_u32_u16 v198, v198, s74, v15
    v_dot2_u32_u16 v199, v199, s74, v15
    v_dot2_u32_u16 v202, v202, s74, v15
    v_dot2_u32_u16 v203, v203, s74, v15
    v_dot2_u32_u16 v206, v206, s74, v15
    v_dot2_u32_u16 v207, v207, s74, v15
    v_mfma_f32_16x16x32_bf16 a[12:15], a[176:179], v[188:191], a[12:15]
    s_waitcnt vmcnt(10)
    s_barrier
    v_mfma_f32_16x16x32_bf16 a[12:15], a[172:175], v[172:175], a[12:15]
    ds_read_b64 v[48:49], v194
    s_waitcnt lgkmcnt(3)
    v_mfma_f32_16x16x32_bf16 a[16:19], a[180:183], v[160:163], a[16:19]
    tbuffer_load_format_d16_xyzw v[222:223], v4, s[28:31], s51 format:[BUF_DATA_FORMAT_32_32_32_32,BUF_NUM_FORMAT_UINT] offen
    v_mfma_f32_16x16x32_bf16 a[16:19], a[184:187], v[176:179], a[16:19]
    ds_read_b64 v[50:51], v195
    v_cvt_pk_bf16_f32 v192, v32, v36
    v_mfma_f32_16x16x32_bf16 a[20:23], a[184:187], v[180:183], a[20:23]
    ds_read_b128 a[168:171], v9 offset:61440
    s_add_u32 m0, m0, s73
    v_mfma_f32_16x16x32_bf16 a[20:23], a[180:183], v[164:167], a[20:23]
    buffer_load_dwordx4 v6, s[4:7], s62 offen lds
    v_mfma_f32_16x16x32_bf16 a[24:27], a[180:183], v[168:171], a[24:27]
    ds_read_b64 v[52:53], v198
    v_cvt_pk_bf16_f32 v193, v40, v44
    v_mfma_f32_16x16x32_bf16 a[24:27], a[184:187], v[184:187], a[24:27]
    ds_read_b64 v[54:55], v199
    s_add_u32 m0, m0, 0x1000
    v_mfma_f32_16x16x32_bf16 a[28:31], a[184:187], v[188:191], a[28:31]
    buffer_load_dwordx4 v7, s[8:11], s61 offen lds
    v_mfma_f32_16x16x32_bf16 a[28:31], a[180:183], v[172:175], a[28:31]
    ds_read_b128 a[172:175], v10 offset:61440
    s_waitcnt lgkmcnt(6)
    v_mfma_f32_16x16x32_bf16 a[32:35], a[160:163], v[160:163], a[32:35]
    ds_read_b64 v[56:57], v202
    v_cvt_pk_bf16_f32 v196, v33, v37
    v_mfma_f32_16x16x32_bf16 a[32:35], a[164:167], v[176:179], a[32:35]
    ds_read_b64 v[58:59], v203
    s_add_u32 m0, m0, s73
    v_mfma_f32_16x16x32_bf16 a[36:39], a[164:167], v[180:183], a[36:39]
    buffer_load_dwordx4 v7, s[4:7], s52 offen lds
    v_mfma_f32_16x16x32_bf16 a[36:39], a[160:163], v[164:167], a[36:39]
    ds_read_b128 a[176:179], v11 offset:0
    v_cvt_pk_bf16_f32 v197, v41, v45
    v_mfma_f32_16x16x32_bf16 a[40:43], a[160:163], v[168:171], a[40:43]
    ds_read_b64 v[60:61], v206
    v_cvt_pk_bf16_f32 v200, v34, v38
    v_mfma_f32_16x16x32_bf16 a[40:43], a[164:167], v[184:187], a[40:43]
    tbuffer_load_format_d16_xyzw v[224:225], v4, s[32:35], s36 format:[BUF_DATA_FORMAT_32_32_32_32,BUF_NUM_FORMAT_UINT] offen
    v_mfma_f32_16x16x32_bf16 a[44:47], a[164:167], v[188:191], a[44:47]
    ds_read_b64 v[62:63], v207
    v_cvt_pk_bf16_f32 v201, v42, v46
    v_mfma_f32_16x16x32_bf16 a[44:47], a[160:163], v[172:175], a[44:47]
    ds_read_b128 a[180:183], v12 offset:0
    s_waitcnt lgkmcnt(6)
    v_mfma_f32_16x16x32_bf16 a[48:51], a[168:171], v[160:163], a[48:51]
    ds_read_b128 a[184:187], v11 offset:4096
    v_cvt_pk_bf16_f32 v204, v35, v39
    v_mfma_f32_16x16x32_bf16 a[48:51], a[172:175], v[176:179], a[48:51]
    tbuffer_load_format_d16_xyzw v[228:229], v4, s[32:35], s37 format:[BUF_DATA_FORMAT_32_32_32_32,BUF_NUM_FORMAT_UINT] offen
    v_mfma_f32_16x16x32_bf16 a[52:55], a[172:175], v[180:183], a[52:55]
    v_cvt_pk_bf16_f32 v205, v43, v47
    v_mfma_f32_16x16x32_bf16 a[52:55], a[168:171], v[164:167], a[52:55]
    v_mfma_f32_16x16x32_bf16 a[56:59], a[168:171], v[168:171], a[56:59]
    ds_read_b128 a[160:163], v12 offset:4096
    s_waitcnt vmcnt(12) lgkmcnt(3)
    v_pk_mul_f32 v[48:49], v[48:49], v[28:29]
    v_pk_mul_f32 v[50:51], v[50:51], v[30:31]
    v_pk_mul_f32 v[52:53], v[52:53], v[28:29]
    v_pk_mul_f32 v[54:55], v[54:55], v[30:31]
    v_pk_mul_f32 v[56:57], v[56:57], v[28:29]
    v_pk_mul_f32 v[58:59], v[58:59], v[30:31]
    v_pk_mul_f32 v[60:61], v[60:61], v[28:29]
    v_pk_mul_f32 v[62:63], v[62:63], v[30:31]
    v_dot2_u32_u16 v208, v208, s74, v15
    v_dot2_u32_u16 v209, v209, s74, v15
    v_dot2_u32_u16 v212, v212, s74, v15
    v_dot2_u32_u16 v213, v213, s74, v15
    v_dot2_u32_u16 v216, v216, s74, v15
    v_dot2_u32_u16 v217, v217, s74, v15
    v_dot2_u32_u16 v220, v220, s74, v15
    v_dot2_u32_u16 v221, v221, s74, v15
    v_mfma_f32_16x16x32_bf16 a[56:59], a[172:175], v[184:187], a[56:59]
    tbuffer_load_format_d16_xyzw v[232:233], v4, s[32:35], s38 format:[BUF_DATA_FORMAT_32_32_32_32,BUF_NUM_FORMAT_UINT] offen
    v_mfma_f32_16x16x32_bf16 a[60:63], a[172:175], v[188:191], a[60:63]
    s_waitcnt vmcnt(10)
    s_barrier
    v_mfma_f32_16x16x32_bf16 a[60:63], a[168:171], v[172:175], a[60:63]
    ds_read_b64 v[32:33], v208
    s_waitcnt lgkmcnt(3)
    v_mfma_f32_16x16x32_bf16 a[64:67], a[176:179], v[160:163], a[64:67]
    tbuffer_load_format_d16_xyzw v[236:237], v4, s[32:35], s39 format:[BUF_DATA_FORMAT_32_32_32_32,BUF_NUM_FORMAT_UINT] offen
    v_mfma_f32_16x16x32_bf16 a[64:67], a[180:183], v[176:179], a[64:67]
    ds_read_b64 v[34:35], v209
    v_cvt_pk_bf16_f32 v194, v48, v52
    v_mfma_f32_16x16x32_bf16 a[68:71], a[180:183], v[180:183], a[68:71]
    ds_read_b64 v[36:37], v212
    s_mov_b32 m0, s72
    v_mfma_f32_16x16x32_bf16 a[68:71], a[176:179], v[164:167], a[68:71]
    buffer_load_dwordx4 v7, s[4:7], s53 offen lds
    v_mfma_f32_16x16x32_bf16 a[72:75], a[176:179], v[168:171], a[72:75]
    ds_read_b128 a[164:167], v11 offset:8192
    v_cvt_pk_bf16_f32 v195, v56, v60
    v_mfma_f32_16x16x32_bf16 a[72:75], a[180:183], v[184:187], a[72:75]
    ds_read_b64 v[38:39], v213
    s_add_u32 m0, m0, 0x1000
    v_mfma_f32_16x16x32_bf16 a[76:79], a[180:183], v[188:191], a[76:79]
    buffer_load_dwordx4 v7, s[4:7], s54 offen lds
    v_mfma_f32_16x16x32_bf16 a[76:79], a[176:179], v[172:175], a[76:79]
    ds_read_b64 v[40:41], v216
    s_waitcnt lgkmcnt(6)
    v_mfma_f32_16x16x32_bf16 a[80:83], a[184:187], v[160:163], a[80:83]
    ds_read_b128 a[168:171], v12 offset:8192
    v_cvt_pk_bf16_f32 v198, v49, v53
    v_mfma_f32_16x16x32_bf16 a[80:83], a[160:163], v[176:179], a[80:83]
    ds_read_b64 v[42:43], v217
    s_add_u32 m0, m0, s73
    v_mfma_f32_16x16x32_bf16 a[84:87], a[160:163], v[180:183], a[84:87]
    buffer_load_dwordx4 v7, s[4:7], s55 offen lds
    v_mfma_f32_16x16x32_bf16 a[84:87], a[184:187], v[164:167], a[84:87]
    ds_read_b64 v[44:45], v220
    v_cvt_pk_bf16_f32 v199, v57, v61
    v_mfma_f32_16x16x32_bf16 a[88:91], a[184:187], v[168:171], a[88:91]
    ds_read_b128 a[172:175], v11 offset:12288
    v_cvt_pk_bf16_f32 v202, v50, v54
    v_mfma_f32_16x16x32_bf16 a[88:91], a[160:163], v[184:187], a[88:91]
    tbuffer_load_format_d16_xyzw v[226:227], v4, s[32:35], s40 format:[BUF_DATA_FORMAT_32_32_32_32,BUF_NUM_FORMAT_UINT] offen
    v_mfma_f32_16x16x32_bf16 a[92:95], a[160:163], v[188:191], a[92:95]
    ds_read_b64 v[46:47], v221
    v_cvt_pk_bf16_f32 v203, v58, v62
    v_mfma_f32_16x16x32_bf16 a[92:95], a[184:187], v[172:175], a[92:95]
    ds_read_b128 a[176:179], v12 offset:12288
    s_waitcnt lgkmcnt(5)
    v_mfma_f32_16x16x32_bf16 a[96:99], a[164:167], v[160:163], a[96:99]
    ds_read_b128 a[180:183], v11 offset:16384
    v_cvt_pk_bf16_f32 v206, v51, v55
    v_mfma_f32_16x16x32_bf16 a[96:99], a[168:171], v[176:179], a[96:99]
    tbuffer_load_format_d16_xyzw v[230:231], v4, s[32:35], s41 format:[BUF_DATA_FORMAT_32_32_32_32,BUF_NUM_FORMAT_UINT] offen
    v_mfma_f32_16x16x32_bf16 a[100:103], a[168:171], v[180:183], a[100:103]
    v_cvt_pk_bf16_f32 v207, v59, v63
    s_waitcnt vmcnt(12) lgkmcnt(2)
    v_pk_mul_f32 v[32:33], v[32:33], v[28:29]
    v_pk_mul_f32 v[34:35], v[34:35], v[30:31]
    v_pk_mul_f32 v[36:37], v[36:37], v[28:29]
    v_pk_mul_f32 v[38:39], v[38:39], v[30:31]
    v_pk_mul_f32 v[40:41], v[40:41], v[28:29]
    v_pk_mul_f32 v[42:43], v[42:43], v[30:31]
    v_pk_mul_f32 v[44:45], v[44:45], v[28:29]
    v_pk_mul_f32 v[46:47], v[46:47], v[30:31]
    v_dot2_u32_u16 v210, v210, s74, v15
    v_dot2_u32_u16 v211, v211, s74, v15
    v_dot2_u32_u16 v214, v214, s74, v15
    v_dot2_u32_u16 v215, v215, s74, v15
    v_dot2_u32_u16 v218, v218, s74, v15
    v_dot2_u32_u16 v219, v219, s74, v15
    v_dot2_u32_u16 v222, v222, s74, v15
    v_dot2_u32_u16 v223, v223, s74, v15
    v_mfma_f32_16x16x32_bf16 a[100:103], a[164:167], v[164:167], a[100:103]
    ds_read_b64 v[48:49], v210
    v_cvt_pk_bf16_f32 v208, v32, v36
    v_cvt_pk_bf16_f32 v221, v43, v47
    v_mfma_f32_16x16x32_bf16 a[104:107], a[164:167], v[168:171], a[104:107]
    tbuffer_load_format_d16_xyzw v[234:235], v4, s[32:35], s42 format:[BUF_DATA_FORMAT_32_32_32_32,BUF_NUM_FORMAT_UINT] offen
    v_mfma_f32_16x16x32_bf16 a[104:107], a[168:171], v[184:187], a[104:107]
    ds_read_b64 v[50:51], v211
    v_cvt_pk_bf16_f32 v209, v40, v44
    v_mfma_f32_16x16x32_bf16 a[108:111], a[168:171], v[188:191], a[108:111]
    s_waitcnt vmcnt(10)
    s_barrier
    v_mfma_f32_16x16x32_bf16 a[108:111], a[164:167], v[172:175], a[108:111]
    ds_read_b128 a[184:187], v12 offset:16384
    s_waitcnt lgkmcnt(4)
    v_mfma_f32_16x16x32_bf16 a[112:115], a[172:175], v[160:163], a[112:115]
    tbuffer_load_format_d16_xyzw v[238:239], v4, s[32:35], s43 format:[BUF_DATA_FORMAT_32_32_32_32,BUF_NUM_FORMAT_UINT] offen
    v_mfma_f32_16x16x32_bf16 a[112:115], a[176:179], v[176:179], a[112:115]
    ds_read_b64 v[52:53], v214
    v_cvt_pk_bf16_f32 v212, v33, v37
    v_mfma_f32_16x16x32_bf16 a[116:119], a[176:179], v[180:183], a[116:119]
    ds_read_b64 v[54:55], v215
    s_add_u32 m0, m0, s73
    v_mfma_f32_16x16x32_bf16 a[116:119], a[172:175], v[164:167], a[116:119]
    buffer_load_dwordx4 v7, s[4:7], s56 offen lds
    v_mfma_f32_16x16x32_bf16 a[120:123], a[172:175], v[168:171], a[120:123]
    ds_read_b128 a[160:163], v11 offset:20480
    v_cvt_pk_bf16_f32 v213, v41, v45
    v_mfma_f32_16x16x32_bf16 a[120:123], a[176:179], v[184:187], a[120:123]
    ds_read_b64 v[56:57], v218
    s_add_u32 m0, m0, 0x1000
L_pg1_standalone__normalfloat_lut_nf4__prompt_kernel:
.if (L_pg1_standalone__normalfloat_lut_nf4__prompt_kernel-L_pg0_standalone__normalfloat_lut_nf4__prompt_kernel) != 4112
.error "size model"
.endif
    s_cbranch_execz L_ret_standalone__normalfloat_lut_nf4__prompt_kernel
    v_mfma_f32_16x16x32_bf16 a[124:127], a[176:179], v[188:191], a[124:127]
    buffer_load_dwordx4 v7, s[4:7], s57 offen lds
    v_mfma_f32_16x16x32_bf16 a[124:127], a[172:175], v[172:175], a[124:127]
    ds_read_b64 v[58:59], v219
    s_waitcnt lgkmcnt(5)
    v_mfma_f32_16x16x32_bf16 a[128:131], a[180:183], v[160:163], a[128:131]
    ds_read_b128 a[164:167], v12 offset:20480
    v_cvt_pk_bf16_f32 v216, v34, v38
    v_mfma_f32_16x16x32_bf16 a[128:131], a[184:187], v[176:179], a[128:131]
    ds_read_b64 v[60:61], v222
    s_add_u32 m0, m0, 0x1000
    v_mfma_f32_16x16x32_bf16 a[132:135], a[184:187], v[180:183], a[132:135]
    buffer_load_dwordx4 v7, s[4:7], s58 offen lds
    v_mfma_f32_16x16x32_bf16 a[132:135], a[180:183], v[164:167], a[132:135]
    ds_read_b64 v[62:63], v223
    v_xor_b32 v13, s75, v11
    v_mfma_f32_16x16x32_bf16 a[136:139], a[180:183], v[168:171], a[136:139]
    ds_read_b128 a[168:171], v13 offset:24576
    v_xor_b32 v14, s75, v12
    v_mfma_f32_16x16x32_bf16 a[136:139], a[184:187], v[184:187], a[136:139]
    tbuffer_load_format_d16_xyzw v[240:241], v4, s[32:35], s44 format:[BUF_DATA_FORMAT_32_32_32_32,BUF_NUM_FORMAT_UINT] offen
    v_mfma_f32_16x16x32_bf16 a[140:143], a[184:187], v[188:191], a[140:143]
    ds_read_b128 a[172:175], v14 offset:24576
    v_cvt_pk_bf16_f32 v217, v42, v46
    v_mfma_f32_16x16x32_bf16 a[140:143], a[180:183], v[172:175], a[140:143]
    v_cvt_pk_bf16_f32 v220, v35, v39
    s_waitcnt lgkmcnt(4)
    v_mfma_f32_16x16x32_bf16 v[76:79], a[160:163], v[172:175], v[76:79]
    ds_read_b128 a[176:179], v11 offset:28672
    s_waitcnt vmcnt(11) lgkmcnt(3)
    v_pk_mul_f32 v[48:49], v[48:49], v[28:29]
    v_pk_mul_f32 v[50:51], v[50:51], v[30:31]
    v_pk_mul_f32 v[52:53], v[52:53], v[28:29]
    v_pk_mul_f32 v[54:55], v[54:55], v[30:31]
    v_pk_mul_f32 v[56:57], v[56:57], v[28:29]
    v_pk_mul_f32 v[58:59], v[58:59], v[30:31]
    v_pk_mul_f32 v[60:61], v[60:61], v[28:29]
    v_pk_mul_f32 v[62:63], v[62:63], v[30:31]
    v_dot2_u32_u16 v224, v224, s74, v15
    v_dot2_u32_u16 v225, v225, s74, v15
    v_dot2_u32_u16 v228, v228, s74, v15
    v_dot2_u32_u16 v229, v229, s74, v15
    v_dot2_u32_u16 v232, v232, s74, v15
    v_dot2_u32_u16 v233, v233, s74, v15
    v_dot2_u32_u16 v236, v236, s74, v15
    v_dot2_u32_u16 v237, v237, s74, v15
    v_mfma_f32_16x16x32_bf16 v[76:79], a[164:167], v[188:191], v[76:79]
    tbuffer_load_format_d16_xyzw v[244:245], v4, s[32:35], s45 format:[BUF_DATA_FORMAT_32_32_32_32,BUF_NUM_FORMAT_UINT] offen
    v_cvt_pk_bf16_f32 v215, v57, v61
    v_cvt_pk_bf16_f32 v218, v50, v54
    v_cvt_pk_bf16_f32 v219, v58, v62
    v_cvt_pk_bf16_f32 v222, v51, v55
    v_cvt_pk_bf16_f32 v223, v59, v63
    v_mfma_f32_16x16x32_bf16 v[72:75], a[164:167], v[184:187], v[72:75]
    ds_read_b64 v[32:33], v224
    v_cvt_pk_bf16_f32 v210, v48, v52
    v_mfma_f32_16x16x32_bf16 v[72:75], a[160:163], v[168:171], v[72:75]
    ds_read_b64 v[34:35], v225
    v_cvt_pk_bf16_f32 v211, v56, v60
    v_mfma_f32_16x16x32_bf16 v[68:71], a[160:163], v[164:167], v[68:71]
    tbuffer_load_format_d16_xyzw v[248:249], v4, s[32:35], s46 format:[BUF_DATA_FORMAT_32_32_32_32,BUF_NUM_FORMAT_UINT] offen
    v_mfma_f32_16x16x32_bf16 v[68:71], a[164:167], v[180:183], v[68:71]
    ds_read_b64 v[36:37], v228
    v_cvt_pk_bf16_f32 v214, v49, v53
    v_mfma_f32_16x16x32_bf16 v[64:67], a[164:167], v[176:179], v[64:67]
    s_waitcnt vmcnt(10)
    s_barrier
    v_mfma_f32_16x16x32_bf16 v[64:67], a[160:163], v[160:163], v[64:67]
    ds_read_b128 a[180:183], v12 offset:28672
    s_waitcnt lgkmcnt(5)
    v_mfma_f32_16x16x32_bf16 a[144:147], a[168:171], v[192:195], a[144:147]
    tbuffer_load_format_d16_xyzw v[252:253], v4, s[32:35], s47 format:[BUF_DATA_FORMAT_32_32_32_32,BUF_NUM_FORMAT_UINT] offen
    v_mfma_f32_16x16x32_bf16 a[144:147], a[172:175], v[208:211], a[144:147]
    ds_read_b64 v[38:39], v229
    v_mfma_f32_16x16x32_bf16 a[148:151], a[172:175], v[212:215], a[148:151]
    ds_read_b64 v[40:41], v232
    s_add_u32 m0, m0, s73
    v_mfma_f32_16x16x32_bf16 a[148:151], a[168:171], v[196:199], a[148:151]
    buffer_load_dwordx4 v7, s[4:7], s59 offen lds
    v_mfma_f32_16x16x32_bf16 a[152:155], a[168:171], v[200:203], a[152:155]
    ds_read_b128 a[184:187], v9 offset:0
    v_mfma_f32_16x16x32_bf16 a[152:155], a[172:175], v[216:219], a[152:155]
    ds_read_b64 v[42:43], v233
    s_add_u32 m0, m0, 0x1000
    v_mfma_f32_16x16x32_bf16 a[156:159], a[172:175], v[220:223], a[156:159]
    buffer_load_dwordx4 v7, s[4:7], s60 offen lds
    v_mfma_f32_16x16x32_bf16 a[156:159], a[168:171], v[204:207], a[156:159]
    ds_read_b64 v[44:45], v236
    s_waitcnt lgkmcnt(5)
    v_mfma_f32_16x16x32_bf16 a[0:3], a[176:179], v[192:195], a[0:3]
    ds_read_b128 a[160:163], v10 offset:0
    s_add_u32 m0, m0, s73
    v_mfma_f32_16x16x32_bf16 a[0:3], a[180:183], v[208:211], a[0:3]
    buffer_load_dwordx4 v7, s[4:7], s62 offen lds
    v_mfma_f32_16x16x32_bf16 a[4:7], a[180:183], v[212:215], a[4:7]
    ds_read_b64 v[46:47], v237
    v_mfma_f32_16x16x32_bf16 a[4:7], a[176:179], v[196:199], a[4:7]
    ds_read_b128 a[164:167], v9 offset:4096
    v_mfma_f32_16x16x32_bf16 a[8:11], a[176:179], v[200:203], a[8:11]
    ds_read_b128 a[168:171], v10 offset:4096
    v_mfma_f32_16x16x32_bf16 a[8:11], a[180:183], v[216:219], a[8:11]
    tbuffer_load_format_d16_xyzw v[242:243], v4, s[32:35], s48 format:[BUF_DATA_FORMAT_32_32_32_32,BUF_NUM_FORMAT_UINT] offen
    v_mfma_f32_16x16x32_bf16 a[12:15], a[180:183], v[220:223], a[12:15]
    s_nop 0
    s_waitcnt vmcnt(11) lgkmcnt(2)
    v_pk_mul_f32 v[32:33], v[32:33], v[28:29]
    v_pk_mul_f32 v[34:35], v[34:35], v[30:31]
    v_pk_mul_f32 v[36:37], v[36:37], v[28:29]
    v_pk_mul_f32 v[38:39], v[38:39], v[30:31]
    v_pk_mul_f32 v[40:41], v[40:41], v[28:29]
    v_pk_mul_f32 v[42:43], v[42:43], v[30:31]
    v_pk_mul_f32 v[44:45], v[44:45], v[28:29]
    v_pk_mul_f32 v[46:47], v[46:47], v[30:31]
    v_dot2_u32_u16 v226, v226, s74, v15
    v_dot2_u32_u16 v227, v227, s74, v15
    v_dot2_u32_u16 v230, v230, s74, v15
    v_dot2_u32_u16 v231, v231, s74, v15
    v_dot2_u32_u16 v234, v234, s74, v15
    v_dot2_u32_u16 v235, v235, s74, v15
    v_dot2_u32_u16 v238, v238, s74, v15
    v_dot2_u32_u16 v239, v239, s74, v15
    v_mfma_f32_16x16x32_bf16 a[12:15], a[176:179], v[204:207], a[12:15]
    ds_read_b64 v[48:49], v226
    v_mfma_f32_16x16x32_bf16 a[16:19], a[184:187], v[192:195], a[16:19]
    tbuffer_load_format_d16_xyzw v[246:247], v4, s[32:35], s49 format:[BUF_DATA_FORMAT_32_32_32_32,BUF_NUM_FORMAT_UINT] offen
    v_mfma_f32_16x16x32_bf16 a[16:19], a[160:163], v[208:211], a[16:19]
    ds_read_b64 v[50:51], v227
    v_cvt_pk_bf16_f32 v224, v32, v36
    v_mfma_f32_16x16x32_bf16 a[20:23], a[160:163], v[212:215], a[20:23]
    ds_read_b128 a[172:175], v9 offset:8192
    v_cvt_pk_bf16_f32 v225, v40, v44
    v_mfma_f32_16x16x32_bf16 a[20:23], a[184:187], v[196:199], a[20:23]
    ds_read_b64 v[52:53], v230
    v_cvt_pk_bf16_f32 v228, v33, v37
    v_mfma_f32_16x16x32_bf16 a[24:27], a[184:187], v[200:203], a[24:27]
    tbuffer_load_format_d16_xyzw v[250:251], v4, s[32:35], s50 format:[BUF_DATA_FORMAT_32_32_32_32,BUF_NUM_FORMAT_UINT] offen
    v_mfma_f32_16x16x32_bf16 a[24:27], a[160:163], v[216:219], a[24:27]
    ds_read_b64 v[54:55], v231
    v_cvt_pk_bf16_f32 v229, v41, v45
    v_mfma_f32_16x16x32_bf16 a[28:31], a[160:163], v[220:223], a[28:31]
    ds_read_b64 v[56:57], v234
    s_waitcnt vmcnt(10)
    s_barrier
    v_mfma_f32_16x16x32_bf16 a[28:31], a[184:187], v[204:207], a[28:31]
    ds_read_b128 a[176:179], v10 offset:8192
    s_waitcnt lgkmcnt(7)
    v_mfma_f32_16x16x32_bf16 a[32:35], a[164:167], v[192:195], a[32:35]
    tbuffer_load_format_d16_xyzw v[254:255], v4, s[32:35], s51 format:[BUF_DATA_FORMAT_32_32_32_32,BUF_NUM_FORMAT_UINT] offen
    v_mfma_f32_16x16x32_bf16 a[32:35], a[168:171], v[208:211], a[32:35]
    ds_read_b64 v[58:59], v235
    s_add_u32 m0, m0, s73
    v_mfma_f32_16x16x32_bf16 a[36:39], a[168:171], v[212:215], a[36:39]
    buffer_load_dwordx4 v8, s[4:7], s52 offen lds
    v_mfma_f32_16x16x32_bf16 a[36:39], a[164:167], v[196:199], a[36:39]
    ds_read_b128 a[180:183], v9 offset:12288
    v_cvt_pk_bf16_f32 v232, v34, v38
    v_mfma_f32_16x16x32_bf16 a[40:43], a[164:167], v[200:203], a[40:43]
    ds_read_b64 v[60:61], v238
    v_cvt_pk_bf16_f32 v233, v42, v46
    v_mfma_f32_16x16x32_bf16 a[40:43], a[168:171], v[216:219], a[40:43]
    ds_read_b64 v[62:63], v239
    s_add_u32 m0, m0, 0x1000
    v_mfma_f32_16x16x32_bf16 a[44:47], a[168:171], v[220:223], a[44:47]
    buffer_load_dwordx4 v8, s[4:7], s62 offen lds
    v_mfma_f32_16x16x32_bf16 a[44:47], a[164:167], v[204:207], a[44:47]
    ds_read_b128 a[184:187], v10 offset:12288
    s_waitcnt lgkmcnt(5)
    v_mfma_f32_16x16x32_bf16 a[48:51], a[172:175], v[192:195], a[48:51]
    ds_read_b128 a[160:163], v9 offset:16384
    s_add_u32 m0, m0, s73
    v_mfma_f32_16x16x32_bf16 a[48:51], a[176:179], v[208:211], a[48:51]
    buffer_load_dwordx4 v8, s[4:7], s53 offen lds
    v_mfma_f32_16x16x32_bf16 a[52:55], a[176:179], v[212:215], a[52:55]
    v_cvt_pk_bf16_f32 v236, v35, v39
    v_cvt_pk_bf16_f32 v237, v43, v47
    v_mfma_f32_16x16x32_bf16 a[52:55], a[172:175], v[196:199], a[52:55]
    s_add_u32 m0, m0, 0x1000
    v_mfma_f32_16x16x32_bf16 a[56:59], a[172:175], v[200:203], a[56:59]
    ds_read_b128 a[164:167], v10 offset:16384
    s_nop 0
    s_waitcnt vmcnt(10) lgkmcnt(3)
    v_pk_mul_f32 v[48:49], v[48:49], v[28:29]
    v_pk_mul_f32 v[50:51], v[50:51], v[30:31]
    v_pk_mul_f32 v[52:53], v[52:53], v[28:29]
    v_pk_mul_f32 v[54:55], v[54:55], v[30:31]
    v_pk_mul_f32 v[56:57], v[56:57], v[28:29]
    v_pk_mul_f32 v[58:59], v[58:59], v[30:31]
    v_pk_mul_f32 v[60:61], v[60:61], v[28:29]
    v_pk_mul_f32 v[62:63], v[62:63], v[30:31]
    v_dot2_u32_u16 v240, v240, s74, v15
    v_dot2_u32_u16 v241, v241, s74, v15
    v_dot2_u32_u16 v244, v244, s74, v15
    v_dot2_u32_u16 v245, v245, s74, v15
    v_dot2_u32_u16 v248, v248, s74, v15
    v_dot2_u32_u16 v249, v249, s74, v15
    v_dot2_u32_u16 v252, v252, s74, v15
    v_dot2_u32_u16 v253, v253, s74, v15
    v_mfma_f32_16x16x32_bf16 a[56:59], a[176:179], v[216:219], a[56:59]
    buffer_load_dwordx4 v8, s[4:7], s54 offen lds
    v_cvt_pk_bf16_f32 v238, v51, v55
    v_cvt_pk_bf16_f32 v239, v59, v63
    v_mfma_f32_16x16x32_bf16 a[60:63], a[176:179], v[220:223], a[60:63]
    ds_read_b64 v[32:33], v240
    s_add_u32 m0, m0, 0x1000
    v_mfma_f32_16x16x32_bf16 a[60:63], a[172:175], v[204:207], a[60:63]
    ds_read_b64 v[34:35], v241
    s_waitcnt lgkmcnt(4)
    v_mfma_f32_16x16x32_bf16 a[64:67], a[180:183], v[192:195], a[64:67]
    buffer_load_dwordx4 v8, s[4:7], s55 offen lds
    v_mfma_f32_16x16x32_bf16 a[64:67], a[184:187], v[208:211], a[64:67]
    ds_read_b64 v[36:37], v244
    v_cvt_pk_bf16_f32 v226, v48, v52
    v_mfma_f32_16x16x32_bf16 a[68:71], a[184:187], v[212:215], a[68:71]
    ds_read_b128 a[168:171], v9 offset:20480
    s_add_u32 m0, m0, s73
    v_mfma_f32_16x16x32_bf16 a[68:71], a[180:183], v[196:199], a[68:71]
    buffer_load_dwordx4 v8, s[4:7], s56 offen lds
    v_mfma_f32_16x16x32_bf16 a[72:75], a[180:183], v[200:203], a[72:75]
    ds_read_b64 v[38:39], v245
    v_cvt_pk_bf16_f32 v227, v56, v60
    v_mfma_f32_16x16x32_bf16 a[72:75], a[184:187], v[216:219], a[72:75]
    ds_read_b64 v[40:41], v248
    s_add_u32 m0, m0, 0x1000
    v_mfma_f32_16x16x32_bf16 a[76:79], a[184:187], v[220:223], a[76:79]
    ds_read_b64 v[42:43], v249
    s_waitcnt vmcnt(10)
    s_barrier
    v_mfma_f32_16x16x32_bf16 a[76:79], a[180:183], v[204:207], a[76:79]
    ds_read_b128 a[172:175], v10 offset:20480
    s_waitcnt lgkmcnt(8)
    v_mfma_f32_16x16x32_bf16 a[80:83], a[160:163], v[192:195], a[80:83]
    buffer_load_dwordx4 v8, s[4:7], s57 offen lds
    v_mfma_f32_16x16x32_bf16 a[80:83], a[164:167], v[208:211], a[80:83]
    ds_read_b64 v[44:45], v252
    s_add_u32 m0, m0, s73
    v_mfma_f32_16x16x32_bf16 a[84:87], a[164:167], v[212:215], a[84:87]
    buffer_load_dwordx4 v8, s[4:7], s58 offen lds
    v_mfma_f32_16x16x32_bf16 a[84:87], a[160:163], v[196:199], a[84:87]
    ds_read_b128 a[176:179], v9 offset:24576
    v_cvt_pk_bf16_f32 v230, v49, v53
    v_mfma_f32_16x16x32_bf16 a[88:91], a[160:163], v[200:203], a[88:91]
    ds_read_b64 v[46:47], v253
    v_cvt_pk_bf16_f32 v231, v57, v61
    v_mfma_f32_16x16x32_bf16 a[88:91], a[164:167], v[216:219], a[88:91]
    ds_read_b128 a[180:183], v10 offset:24576
    s_add_u32 m0, m0, 0x1000
    v_mfma_f32_16x16x32_bf16 a[92:95], a[164:167], v[220:223], a[92:95]
    buffer_load_dwordx4 v8, s[8:11], s61 offen lds
    v_mfma_f32_16x16x32_bf16 a[92:95], a[160:163], v[204:207], a[92:95]
    v_cvt_pk_bf16_f32 v234, v50, v54
    s_waitcnt lgkmcnt(4)
    v_mfma_f32_16x16x32_bf16 a[96:99], a[168:171], v[192:195], a[96:99]
    ds_read_b128 a[184:187], v9 offset:28672
    s_add_u32 m0, m0, s73
    v_mfma_f32_16x16x32_bf16 a[96:99], a[172:175], v[208:211], a[96:99]
    buffer_load_dwordx4 v5, s[4:7], s63 offen lds
    v_mfma_f32_16x16x32_bf16 a[100:103], a[172:175], v[212:215], a[100:103]
    v_cvt_pk_bf16_f32 v235, v58, v62
    s_nop 0
    s_waitcnt vmcnt(10) lgkmcnt(2)
    v_pk_mul_f32 v[32:33], v[32:33], v[28:29]
    v_pk_mul_f32 v[34:35], v[34:35], v[30:31]
    v_pk_mul_f32 v[36:37], v[36:37], v[28:29]
    v_pk_mul_f32 v[38:39], v[38:39], v[30:31]
    v_pk_mul_f32 v[40:41], v[40:41], v[28:29]
    v_pk_mul_f32 v[42:43], v[42:43], v[30:31]
    v_pk_mul_f32 v[44:45], v[44:45], v[28:29]
    v_pk_mul_f32 v[46:47], v[46:47], v[30:31]
    v_dot2_u32_u16 v242, v242, s74, v15
    v_dot2_u32_u16 v243, v243, s74, v15
    v_dot2_u32_u16 v246, v246, s74, v15
    v_dot2_u32_u16 v247, v247, s74, v15
    v_dot2_u32_u16 v250, v250, s74, v15
    v_dot2_u32_u16 v251, v251, s74, v15
    v_dot2_u32_u16 v254, v254, s74, v15
    v_dot2_u32_u16 v255, v255, s74, v15
    v_mfma_f32_16x16x32_bf16 a[100:103], a[168:171], v[196:199], a[100:103]
    ds_read_b64 v[48:49], v242
    v_cvt_pk_bf16_f32 v240, v32, v36
    v_mfma_f32_16x16x32_bf16 a[104:107], a[168:171], v[200:203], a[104:107]
    ds_read_b128 a[160:163], v10 offset:28672
    v_cvt_pk_bf16_f32 v241, v40, v44
    v_mfma_f32_16x16x32_bf16 a[104:107], a[172:175], v[216:219], a[104:107]
    ds_read_b64 v[50:51], v243
    s_add_u32 m0, m0, 0x1000
    v_mfma_f32_16x16x32_bf16 a[108:111], a[172:175], v[220:223], a[108:111]
    buffer_load_dwordx4 v6, s[4:7], s63 offen lds
    v_mfma_f32_16x16x32_bf16 a[108:111], a[168:171], v[204:207], a[108:111]
    ds_read_b64 v[52:53], v246
    s_waitcnt lgkmcnt(5)
    v_mfma_f32_16x16x32_bf16 a[112:115], a[176:179], v[192:195], a[112:115]
    ds_read_b64 v[54:55], v247
    v_cvt_pk_bf16_f32 v244, v33, v37
    v_mfma_f32_16x16x32_bf16 a[112:115], a[180:183], v[208:211], a[112:115]
    ds_read_b128 a[164:167], v9 offset:32768
    v_cvt_pk_bf16_f32 v245, v41, v45
    v_mfma_f32_16x16x32_bf16 a[116:119], a[180:183], v[212:215], a[116:119]
    ds_read_b64 v[56:57], v250
    v_cvt_pk_bf16_f32 v248, v34, v38
    v_mfma_f32_16x16x32_bf16 a[116:119], a[176:179], v[196:199], a[116:119]
    ds_read_b128 a[168:171], v10 offset:32768
    v_cvt_pk_bf16_f32 v249, v42, v46
    v_mfma_f32_16x16x32_bf16 a[120:123], a[176:179], v[200:203], a[120:123]
    ds_read_b64 v[58:59], v251
    s_add_u32 m0, m0, s73
    v_mfma_f32_16x16x32_bf16 a[120:123], a[180:183], v[216:219], a[120:123]
    buffer_load_dwordx4 v7, s[4:7], s63 offen lds
    v_mfma_f32_16x16x32_bf16 a[124:127], a[180:183], v[220:223], a[124:127]
    s_waitcnt vmcnt(9)
    s_barrier
    v_mfma_f32_16x16x32_bf16 a[124:127], a[176:179], v[204:207], a[124:127]
    ds_read_b64 v[60:61], v254
    s_waitcnt lgkmcnt(8)
    v_mfma_f32_16x16x32_bf16 a[128:131], a[184:187], v[192:195], a[128:131]
    ds_read_b64 v[62:63], v255
    v_cvt_pk_bf16_f32 v252, v35, v39
    v_mfma_f32_16x16x32_bf16 a[128:131], a[160:163], v[208:211], a[128:131]
    ds_read_b128 a[172:175], v9 offset:36864
    v_cvt_pk_bf16_f32 v253, v43, v47
    v_mfma_f32_16x16x32_bf16 a[132:135], a[160:163], v[212:215], a[132:135]
    v_mfma_f32_16x16x32_bf16 a[132:135], a[184:187], v[196:199], a[132:135]
    s_add_u32 m0, m0, s73
    v_mfma_f32_16x16x32_bf16 a[136:139], a[184:187], v[200:203], a[136:139]
    buffer_load_dwordx4 v8, s[4:7], s63 offen lds
    v_mfma_f32_16x16x32_bf16 a[136:139], a[160:163], v[216:219], a[136:139]
    ds_read_b128 a[176:179], v10 offset:36864
    v_mfma_f32_16x16x32_bf16 a[140:143], a[160:163], v[220:223], a[140:143]
    v_mfma_f32_16x16x32_bf16 a[140:143], a[184:187], v[204:207], a[140:143]
    s_waitcnt lgkmcnt(5)
    v_mfma_f32_16x16x32_bf16 v[64:67], a[164:167], v[192:195], v[64:67]
    s_waitcnt lgkmcnt(2)
    v_pk_mul_f32 v[48:49], v[48:49], v[28:29]
    v_pk_mul_f32 v[50:51], v[50:51], v[30:31]
    v_pk_mul_f32 v[52:53], v[52:53], v[28:29]
    v_pk_mul_f32 v[54:55], v[54:55], v[30:31]
    v_pk_mul_f32 v[56:57], v[56:57], v[28:29]
    v_pk_mul_f32 v[58:59], v[58:59], v[30:31]
    v_pk_mul_f32 v[60:61], v[60:61], v[28:29]
    v_pk_mul_f32 v[62:63], v[62:63], v[30:31]
    v_mfma_f32_16x16x32_bf16 v[64:67], a[168:171], v[208:211], v[64:67]
    ds_read_b128 a[180:183], v9 offset:40960
    v_cvt_pk_bf16_f32 v242, v48, v52
    v_mfma_f32_16x16x32_bf16 v[68:71], a[168:171], v[212:215], v[68:71]
    s_add_u32 m0, m0, 0x1000
    v_cvt_pk_bf16_f32 v243, v56, v60
    v_cvt_pk_bf16_f32 v246, v49, v53
    v_mfma_f32_16x16x32_bf16 v[68:71], a[164:167], v[196:199], v[68:71]
    buffer_load_dwordx4 v8, s[4:7], s59 offen lds
    v_mfma_f32_16x16x32_bf16 v[72:75], a[164:167], v[200:203], v[72:75]
    v_cvt_pk_bf16_f32 v247, v57, v61
    v_cvt_pk_bf16_f32 v250, v50, v54
    v_mfma_f32_16x16x32_bf16 v[72:75], a[168:171], v[216:219], v[72:75]
    ds_read_b128 a[184:187], v10 offset:40960
    v_cvt_pk_bf16_f32 v251, v58, v62
    v_mfma_f32_16x16x32_bf16 v[76:79], a[168:171], v[220:223], v[76:79]
    v_cvt_pk_bf16_f32 v254, v51, v55
    v_cvt_pk_bf16_f32 v255, v59, v63
    v_mfma_f32_16x16x32_bf16 v[76:79], a[164:167], v[204:207], v[76:79]
    s_waitcnt lgkmcnt(2)
    v_mfma_f32_16x16x32_bf16 a[0:3], a[172:175], v[224:227], a[0:3]
    v_mfma_f32_16x16x32_bf16 a[0:3], a[176:179], v[240:243], a[0:3]
    ds_read_b128 a[160:163], v9 offset:45056
    s_add_u32 m0, m0, s73
    v_mfma_f32_16x16x32_bf16 a[4:7], a[176:179], v[244:247], a[4:7]
    buffer_load_dwordx4 v5, s[4:7], s64 offen lds
    v_mfma_f32_16x16x32_bf16 a[4:7], a[172:175], v[228:231], a[4:7]
    v_mfma_f32_16x16x32_bf16 a[8:11], a[172:175], v[232:235], a[8:11]
    v_mfma_f32_16x16x32_bf16 a[8:11], a[176:179], v[248:251], a[8:11]
    ds_read_b128 a[164:167], v10 offset:45056
    v_mfma_f32_16x16x32_bf16 a[12:15], a[176:179], v[252:255], a[12:15]
    s_waitcnt vmcnt(9)
    s_barrier
    v_mfma_f32_16x16x32_bf16 a[12:15], a[172:175], v[236:239], a[12:15]
    s_waitcnt lgkmcnt(2)
    v_mfma_f32_16x16x32_bf16 v[76:79], a[180:183], v[236:239], v[76:79]
    ds_read_b128 a[168:171], v9 offset:49152
    s_mov_b32 m0, s72
    v_mfma_f32_16x16x32_bf16 v[76:79], a[184:187], v[252:255], v[76:79]
    buffer_load_dwordx4 v6, s[4:7], s64 offen lds
    v_mfma_f32_16x16x32_bf16 v[72:75], a[184:187], v[248:251], v[72:75]
    ds_read_b128 a[172:175], v10 offset:49152
    v_mfma_f32_16x16x32_bf16 v[72:75], a[180:183], v[232:235], v[72:75]
    ds_write_b128 v16, a[0:3] offset:0
    v_mfma_f32_16x16x32_bf16 v[68:71], a[180:183], v[228:231], v[68:71]
    v_mfma_f32_16x16x32_bf16 v[68:71], a[184:187], v[244:247], v[68:71]
    v_mfma_f32_16x16x32_bf16 v[64:67], a[184:187], v[240:243], v[64:67]
    ds_write_b128 v16, a[4:7] offset:1024
    v_mfma_f32_16x16x32_bf16 v[64:67], a[180:183], v[224:227], v[64:67]
    s_add_u32 m0, m0, 0x1000
    s_waitcnt lgkmcnt(4)
    v_mfma_f32_16x16x32_bf16 a[16:19], a[160:163], v[224:227], a[16:19]
    buffer_load_dwordx4 v7, s[4:7], s64 offen lds
    v_mfma_f32_16x16x32_bf16 a[16:19], a[164:167], v[240:243], a[16:19]
    ds_write_b128 v16, a[8:11] offset:2048
    v_mfma_f32_16x16x32_bf16 a[20:23], a[164:167], v[244:247], a[20:23]
    v_mfma_f32_16x16x32_bf16 a[20:23], a[160:163], v[228:231], a[20:23]
    v_mfma_f32_16x16x32_bf16 a[24:27], a[160:163], v[232:235], a[24:27]
    ds_write_b128 v16, a[12:15] offset:3072
    v_mfma_f32_16x16x32_bf16 a[24:27], a[164:167], v[248:251], a[24:27]
    s_add_u32 m0, m0, s73
    v_mfma_f32_16x16x32_bf16 a[28:31], a[164:167], v[252:255], a[28:31]
    buffer_load_dwordx4 v8, s[4:7], s64 offen lds
    v_mfma_f32_16x16x32_bf16 a[28:31], a[160:163], v[236:239], a[28:31]
    ds_read_b128 a[176:179], v9 offset:53248
    s_waitcnt lgkmcnt(5)
    v_mfma_f32_16x16x32_bf16 a[32:35], a[168:171], v[224:227], a[32:35]
    ds_read_b128 a[180:183], v10 offset:53248
    v_mfma_f32_16x16x32_bf16 a[32:35], a[172:175], v[240:243], a[32:35]
    ds_read_b128 a[184:187], v9 offset:57344
    v_mfma_f32_16x16x32_bf16 a[36:39], a[172:175], v[244:247], a[36:39]
    ds_read_b128 a[160:163], v10 offset:57344
    v_mfma_f32_16x16x32_bf16 a[36:39], a[168:171], v[228:231], a[36:39]
    s_waitcnt vmcnt(8) lgkmcnt(4)
    s_barrier
    v_mfma_f32_16x16x32_bf16 a[40:43], a[168:171], v[232:235], a[40:43]
    ds_write_b128 v16, a[16:19] offset:16384
    v_mfma_f32_16x16x32_bf16 a[40:43], a[172:175], v[248:251], a[40:43]
    s_add_u32 m0, m0, s73
    v_mfma_f32_16x16x32_bf16 a[44:47], a[172:175], v[252:255], a[44:47]
    buffer_load_dwordx4 v8, s[4:7], s60 offen lds
    v_mfma_f32_16x16x32_bf16 a[44:47], a[168:171], v[236:239], a[44:47]
    ds_read_b128 v[32:35], v17 offset:0
    s_waitcnt lgkmcnt(4)
    v_mfma_f32_16x16x32_bf16 a[48:51], a[176:179], v[224:227], a[48:51]
    ds_read_b128 v[36:39], v17 offset:1024
    v_mfma_f32_16x16x32_bf16 a[48:51], a[180:183], v[240:243], a[48:51]
    ds_read_b128 v[40:43], v17 offset:2048
    ds_read_b128 v[44:47], v17 offset:3072
    v_mfma_f32_16x16x32_bf16 a[52:55], a[180:183], v[244:247], a[52:55]
    ds_read_b128 a[164:167], v9 offset:61440
    v_mfma_f32_16x16x32_bf16 a[52:55], a[176:179], v[228:231], a[52:55]
    ds_write_b128 v16, a[20:23] offset:17408
    v_mfma_f32_16x16x32_bf16 a[56:59], a[176:179], v[232:235], a[56:59]
    s_add_u32 m0, m0, s73
    v_mfma_f32_16x16x32_bf16 a[56:59], a[180:183], v[248:251], a[56:59]
    buffer_load_dwordx4 v5, s[4:7], s65 offen lds
    v_mfma_f32_16x16x32_bf16 a[60:63], a[180:183], v[252:255], a[60:63]
    ds_read_b128 a[168:171], v10 offset:61440
    v_mfma_f32_16x16x32_bf16 a[60:63], a[176:179], v[236:239], a[60:63]
    s_waitcnt lgkmcnt(8)
    v_mfma_f32_16x16x32_bf16 a[64:67], a[184:187], v[224:227], a[64:67]
    ds_read_b128 a[172:175], v11 offset:0
    s_waitcnt lgkmcnt(4)
    v_add_f32 v67, v67, v35
    v_add_f32 v71, v71, v39
    v_add_f32 v75, v75, v43
    v_add_f32 v79, v79, v47
    v_mfma_f32_16x16x32_bf16 a[64:67], a[160:163], v[240:243], a[64:67]
    ds_write_b128 v16, a[24:27] offset:18432
    v_mfma_f32_16x16x32_bf16 a[68:71], a[160:163], v[244:247], a[68:71]
    v_add_f32 v64, v64, v32
    v_add_f32 v68, v68, v36
    v_mfma_f32_16x16x32_bf16 a[68:71], a[184:187], v[228:231], a[68:71]
    s_add_u32 m0, m0, 0x1000
    v_add_f32 v72, v72, v40
    v_add_f32 v76, v76, v44
    v_mfma_f32_16x16x32_bf16 a[72:75], a[184:187], v[232:235], a[72:75]
    buffer_load_dwordx4 v6, s[4:7], s65 offen lds
    v_mfma_f32_16x16x32_bf16 a[72:75], a[160:163], v[248:251], a[72:75]
    ds_read_b128 a[176:179], v12 offset:0
    v_add_f32 v65, v65, v33
    v_mfma_f32_16x16x32_bf16 a[76:79], a[160:163], v[252:255], a[76:79]
    v_xor_b32 v13, s75, v11
    v_add_f32 v69, v69, v37
    v_mfma_f32_16x16x32_bf16 a[76:79], a[184:187], v[236:239], a[76:79]
    ds_read_b128 a[180:183], v13 offset:4096
    s_waitcnt lgkmcnt(4)
    v_mfma_f32_16x16x32_bf16 a[80:83], a[164:167], v[224:227], a[80:83]
    ds_write_b128 v16, a[28:31] offset:19456
    v_mfma_f32_16x16x32_bf16 a[80:83], a[168:171], v[240:243], a[80:83]
    v_add_f32 v73, v73, v41
    v_add_f32 v77, v77, v45
    v_mfma_f32_16x16x32_bf16 a[84:87], a[168:171], v[244:247], a[84:87]
    s_add_u32 m0, m0, 0x1000
    v_add_f32 v66, v66, v34
    v_add_f32 v70, v70, v38
    v_mfma_f32_16x16x32_bf16 a[84:87], a[164:167], v[228:231], a[84:87]
    buffer_load_dwordx4 v7, s[4:7], s65 offen lds
    v_mfma_f32_16x16x32_bf16 a[88:91], a[164:167], v[232:235], a[88:91]
    v_xor_b32 v14, s75, v12
    v_add_f32 v74, v74, v42
    v_mfma_f32_16x16x32_bf16 a[88:91], a[168:171], v[248:251], a[88:91]
    ds_read_b128 a[184:187], v14 offset:4096
    v_add_f32 v78, v78, v46
    v_mfma_f32_16x16x32_bf16 a[92:95], a[168:171], v[252:255], a[92:95]
    v_mfma_f32_16x16x32_bf16 a[92:95], a[164:167], v[236:239], a[92:95]
    v_cvt_pk_bf16_f32 v112, v64, v68
    s_waitcnt lgkmcnt(3)
    v_mfma_f32_16x16x32_bf16 a[96:99], a[172:175], v[224:227], a[96:99]
    v_cvt_pk_bf16_f32 v113, v72, v76
    v_cvt_pk_bf16_f32 v114, v65, v69
    v_mfma_f32_16x16x32_bf16 a[96:99], a[176:179], v[240:243], a[96:99]
    ds_read_b128 a[160:163], v11 offset:8192
    s_add_u32 m0, m0, 0x1000
    v_mfma_f32_16x16x32_bf16 a[100:103], a[176:179], v[244:247], a[100:103]
    buffer_load_dwordx4 v8, s[4:7], s65 offen lds
    v_mfma_f32_16x16x32_bf16 a[100:103], a[172:175], v[228:231], a[100:103]
    s_mul_i32 s71, s62, 9
    s_waitcnt vmcnt(8) lgkmcnt(2)
    s_barrier
    v_mfma_f32_16x16x32_bf16 a[104:107], a[172:175], v[232:235], a[104:107]
    buffer_store_dwordx2 v[112:113], v18, s[12:15], s71 offen sc0 sc1
    v_cvt_pk_bf16_f32 v115, v73, v77
    v_mfma_f32_16x16x32_bf16 a[104:107], a[176:179], v[248:251], a[104:107]
    ds_read_b128 v[80:83], v17 offset:16384
    v_cvt_pk_bf16_f32 v116, v66, v70
    v_mfma_f32_16x16x32_bf16 a[108:111], a[176:179], v[252:255], a[108:111]
    ds_read_b128 a[164:167], v12 offset:8192
    v_cvt_pk_bf16_f32 v117, v74, v78
    v_mfma_f32_16x16x32_bf16 a[108:111], a[172:175], v[236:239], a[108:111]
    ds_read_b128 v[84:87], v17 offset:17408
    s_waitcnt lgkmcnt(4)
    v_mfma_f32_16x16x32_bf16 a[144:147], a[180:183], v[224:227], a[144:147]
    ds_read_b128 v[88:91], v17 offset:18432
    v_cvt_pk_bf16_f32 v118, v67, v71
    v_mfma_f32_16x16x32_bf16 a[144:147], a[184:187], v[240:243], a[144:147]
    ds_read_b128 a[168:171], v11 offset:12288
    ds_read_b128 v[92:95], v17 offset:19456
    v_mfma_f32_16x16x32_bf16 a[148:151], a[184:187], v[244:247], a[148:151]
    buffer_store_dwordx2 v[114:115], v19, s[12:15], s71 offen sc0 sc1
    v_cvt_pk_bf16_f32 v119, v75, v79
    v_mfma_f32_16x16x32_bf16 a[148:151], a[180:183], v[228:231], a[148:151]
    ds_write_b128 v16, a[32:35] offset:32768
    v_mfma_f32_16x16x32_bf16 a[152:155], a[180:183], v[232:235], a[152:155]
    v_mfma_f32_16x16x32_bf16 a[152:155], a[184:187], v[248:251], a[152:155]
    s_add_u32 m0, m0, 0x1000
    v_mfma_f32_16x16x32_bf16 a[156:159], a[184:187], v[252:255], a[156:159]
    buffer_load_dwordx4 v5, s[4:7], s66 offen lds
    v_mfma_f32_16x16x32_bf16 a[156:159], a[180:183], v[236:239], a[156:159]
    ds_read_b128 a[172:175], v12 offset:12288
    s_waitcnt lgkmcnt(2)
    v_mfma_f32_16x16x32_bf16 v[80:83], a[160:163], v[128:131], v[80:83]
    ds_read_b128 a[176:179], v11 offset:16384
    v_mfma_f32_16x16x32_bf16 v[80:83], a[164:167], v[144:147], v[80:83]
    buffer_store_dwordx2 v[116:117], v20, s[12:15], s71 offen sc0 sc1
    v_mfma_f32_16x16x32_bf16 v[84:87], a[164:167], v[148:151], v[84:87]
    ds_write_b128 v16, a[36:39] offset:33792
    v_mfma_f32_16x16x32_bf16 v[84:87], a[160:163], v[132:135], v[84:87]
    v_mfma_f32_16x16x32_bf16 v[88:91], a[160:163], v[136:139], v[88:91]
    s_add_u32 m0, m0, s73
    v_mfma_f32_16x16x32_bf16 v[88:91], a[164:167], v[152:155], v[88:91]
    buffer_load_dwordx4 v6, s[4:7], s66 offen lds
    v_mfma_f32_16x16x32_bf16 v[92:95], a[164:167], v[156:159], v[92:95]
    ds_read_b128 a[180:183], v12 offset:16384
    v_mfma_f32_16x16x32_bf16 v[92:95], a[160:163], v[140:143], v[92:95]
    ds_read_b128 a[184:187], v11 offset:20480
    s_waitcnt lgkmcnt(4)
    v_mfma_f32_16x16x32_bf16 v[92:95], a[168:171], v[172:175], v[92:95]
    buffer_store_dwordx2 v[118:119], v21, s[12:15], s71 offen sc0 sc1
    v_mfma_f32_16x16x32_bf16 v[92:95], a[172:175], v[188:191], v[92:95]
    ds_write_b128 v16, a[40:43] offset:34816
L_pg2_standalone__normalfloat_lut_nf4__prompt_kernel:
.if (L_pg2_standalone__normalfloat_lut_nf4__prompt_kernel-L_pg0_standalone__normalfloat_lut_nf4__prompt_kernel) != 8196
.error "size model"
.endif
    s_cbranch_execz L_ret_standalone__normalfloat_lut_nf4__prompt_kernel
    v_mfma_f32_16x16x32_bf16 v[88:91], a[172:175], v[184:187], v[88:91]
    v_mfma_f32_16x16x32_bf16 v[88:91], a[168:171], v[168:171], v[88:91]
    s_add_u32 m0, m0, 0x1000
    v_mfma_f32_16x16x32_bf16 v[84:87], a[168:171], v[164:167], v[84:87]
    buffer_load_dwordx4 v7, s[4:7], s66 offen lds
    v_mfma_f32_16x16x32_bf16 v[84:87], a[172:175], v[180:183], v[84:87]
    ds_read_b128 a[160:163], v12 offset:20480
    v_mfma_f32_16x16x32_bf16 v[80:83], a[172:175], v[176:179], v[80:83]
    v_mfma_f32_16x16x32_bf16 v[80:83], a[168:171], v[160:163], v[80:83]
    ds_read_b128 a[164:167], v11 offset:24576
    s_waitcnt lgkmcnt(4)
    v_mfma_f32_16x16x32_bf16 v[80:83], a[176:179], v[192:195], v[80:83]
    ds_write_b128 v16, a[44:47] offset:35840
    v_mfma_f32_16x16x32_bf16 v[80:83], a[180:183], v[208:211], v[80:83]
    s_add_u32 m0, m0, s73
    v_mfma_f32_16x16x32_bf16 v[84:87], a[180:183], v[212:215], v[84:87]
    buffer_load_dwordx4 v8, s[4:7], s66 offen lds
    v_mfma_f32_16x16x32_bf16 v[84:87], a[176:179], v[196:199], v[84:87]
    ds_write_b64 v1, a[146:147] offset:0
    v_mfma_f32_16x16x32_bf16 v[88:91], a[176:179], v[200:203], v[88:91]
    ds_read_b128 a[168:171], v12 offset:24576
    v_mfma_f32_16x16x32_bf16 v[88:91], a[180:183], v[216:219], v[88:91]
    ds_write_b64 v1, a[150:151] offset:512
    v_mfma_f32_16x16x32_bf16 v[92:95], a[180:183], v[220:223], v[92:95]
    v_mfma_f32_16x16x32_bf16 v[92:95], a[176:179], v[204:207], v[92:95]
    ds_read_b128 a[172:175], v11 offset:28672
    s_waitcnt lgkmcnt(6)
    v_mfma_f32_16x16x32_bf16 v[92:95], a[184:187], v[236:239], v[92:95]
    s_add_u32 m0, m0, s73
    ds_write_b64 v1, a[154:155] offset:1024
    v_mfma_f32_16x16x32_bf16 v[92:95], a[160:163], v[252:255], v[92:95]
    buffer_load_dwordx4 v5, s[4:7], s67 offen lds
    v_mfma_f32_16x16x32_bf16 v[88:91], a[160:163], v[248:251], v[88:91]
    ds_write_b64 v1, a[158:159] offset:1536
    v_mfma_f32_16x16x32_bf16 v[88:91], a[184:187], v[232:235], v[88:91]
    s_waitcnt vmcnt(12) lgkmcnt(6)
    s_barrier
    v_mfma_f32_16x16x32_bf16 v[84:87], a[184:187], v[228:231], v[84:87]
    ds_read_b128 v[96:99], v17 offset:32768
    v_mfma_f32_16x16x32_bf16 v[84:87], a[160:163], v[244:247], v[84:87]
    ds_read_b128 a[176:179], v12 offset:28672
    v_mfma_f32_16x16x32_bf16 v[80:83], a[160:163], v[240:243], v[80:83]
    ds_read_b128 v[100:103], v17 offset:33792
    v_mfma_f32_16x16x32_bf16 v[80:83], a[184:187], v[224:227], v[80:83]
    ds_read_b128 v[104:107], v17 offset:34816
    s_waitcnt lgkmcnt(8)
    v_mfma_f32_16x16x32_bf16 a[112:115], a[164:167], v[224:227], a[112:115]
    ds_read_b128 v[108:111], v17 offset:35840
    v_mfma_f32_16x16x32_bf16 a[112:115], a[168:171], v[240:243], a[112:115]
    ds_read_b128 a[180:183], v9 offset:0
    v_cvt_pk_bf16_f32 v121, v88, v92
    v_mfma_f32_16x16x32_bf16 a[116:119], a[168:171], v[244:247], a[116:119]
    ds_write_b128 v16, a[48:51] offset:0
    v_mfma_f32_16x16x32_bf16 a[116:119], a[164:167], v[228:231], a[116:119]
    v_cvt_pk_bf16_f32 v123, v89, v93
    v_cvt_pk_bf16_f32 v125, v90, v94
    v_mfma_f32_16x16x32_bf16 a[120:123], a[164:167], v[232:235], a[120:123]
    v_cvt_pk_bf16_f32 v120, v80, v84
    v_cvt_pk_bf16_f32 v122, v81, v85
    v_mfma_f32_16x16x32_bf16 a[120:123], a[168:171], v[248:251], a[120:123]
    ds_read_b128 a[184:187], v10 offset:0
    s_mul_i32 s71, s63, 9
    v_mfma_f32_16x16x32_bf16 a[124:127], a[168:171], v[252:255], a[124:127]
    buffer_store_dwordx2 v[120:121], v18, s[12:15], s71 offen sc0 sc1
    v_cvt_pk_bf16_f32 v124, v82, v86
    v_mfma_f32_16x16x32_bf16 a[124:127], a[164:167], v[236:239], a[124:127]
    v_cvt_pk_bf16_f32 v126, v83, v87
    s_waitcnt lgkmcnt(3)
    v_mfma_f32_16x16x32_bf16 v[96:99], a[172:175], v[128:131], v[96:99]
    ds_read_b128 a[160:163], v9 offset:4096
    v_cvt_pk_bf16_f32 v127, v91, v95
    v_mfma_f32_16x16x32_bf16 v[96:99], a[176:179], v[144:147], v[96:99]
    ds_write_b128 v16, a[52:55] offset:1024
    v_mfma_f32_16x16x32_bf16 v[100:103], a[176:179], v[148:151], v[100:103]
    s_add_u32 m0, m0, s73
    v_mfma_f32_16x16x32_bf16 v[100:103], a[172:175], v[132:135], v[100:103]
    buffer_load_dwordx4 v6, s[4:7], s67 offen lds
    v_mfma_f32_16x16x32_bf16 v[104:107], a[172:175], v[136:139], v[104:107]
    ds_read_b128 a[164:167], v10 offset:4096
    v_mfma_f32_16x16x32_bf16 v[104:107], a[176:179], v[152:155], v[104:107]
    buffer_store_dwordx2 v[122:123], v19, s[12:15], s71 offen sc0 sc1
    v_mfma_f32_16x16x32_bf16 v[108:111], a[176:179], v[156:159], v[108:111]
    v_mfma_f32_16x16x32_bf16 v[108:111], a[172:175], v[140:143], v[108:111]
    ds_read_b128 a[168:171], v9 offset:8192
    s_waitcnt lgkmcnt(4)
    v_mfma_f32_16x16x32_bf16 v[108:111], a[180:183], v[172:175], v[108:111]
    ds_write_b128 v16, a[56:59] offset:2048
    v_mfma_f32_16x16x32_bf16 v[108:111], a[184:187], v[188:191], v[108:111]
    s_add_u32 m0, m0, s73
    v_mfma_f32_16x16x32_bf16 v[104:107], a[184:187], v[184:187], v[104:107]
    buffer_load_dwordx4 v7, s[4:7], s67 offen lds
    v_mfma_f32_16x16x32_bf16 v[104:107], a[180:183], v[168:171], v[104:107]
    v_mfma_f32_16x16x32_bf16 v[100:103], a[180:183], v[164:167], v[100:103]
    buffer_store_dwordx2 v[124:125], v20, s[12:15], s71 offen sc0 sc1
    v_mfma_f32_16x16x32_bf16 v[100:103], a[184:187], v[180:183], v[100:103]
    ds_read_b128 a[172:175], v10 offset:8192
    v_mfma_f32_16x16x32_bf16 v[96:99], a[184:187], v[176:179], v[96:99]
    v_mfma_f32_16x16x32_bf16 v[96:99], a[180:183], v[160:163], v[96:99]
    ds_read_b128 a[176:179], v9 offset:12288
    s_waitcnt lgkmcnt(4)
    v_mfma_f32_16x16x32_bf16 v[96:99], a[160:163], v[192:195], v[96:99]
    s_add_u32 m0, m0, s73
    ds_write_b128 v16, a[60:63] offset:3072
    v_mfma_f32_16x16x32_bf16 v[96:99], a[164:167], v[208:211], v[96:99]
    buffer_load_dwordx4 v8, s[4:7], s67 offen lds
    v_mfma_f32_16x16x32_bf16 v[100:103], a[164:167], v[212:215], v[100:103]
    v_mfma_f32_16x16x32_bf16 v[100:103], a[160:163], v[196:199], v[100:103]
    buffer_store_dwordx2 v[126:127], v21, s[12:15], s71 offen sc0 sc1
    v_mfma_f32_16x16x32_bf16 v[104:107], a[160:163], v[200:203], v[104:107]
    v_mfma_f32_16x16x32_bf16 v[104:107], a[164:167], v[216:219], v[104:107]
    ds_read_b128 a[180:183], v10 offset:12288
    v_mfma_f32_16x16x32_bf16 v[108:111], a[164:167], v[220:223], v[108:111]
    v_mfma_f32_16x16x32_bf16 v[108:111], a[160:163], v[204:207], v[108:111]
    s_waitcnt lgkmcnt(3)
    v_mfma_f32_16x16x32_bf16 v[108:111], a[168:171], v[236:239], v[108:111]
    v_mfma_f32_16x16x32_bf16 v[108:111], a[172:175], v[252:255], v[108:111]
    ds_read_b128 a[184:187], v9 offset:16384
    s_add_u32 m0, m0, s73
    v_mfma_f32_16x16x32_bf16 v[104:107], a[172:175], v[248:251], v[104:107]
    buffer_load_dwordx4 v5, s[4:7], s68 offen lds
    v_mfma_f32_16x16x32_bf16 v[104:107], a[168:171], v[232:235], v[104:107]
    s_waitcnt vmcnt(14) lgkmcnt(2)
    s_barrier
    v_mfma_f32_16x16x32_bf16 v[100:103], a[168:171], v[228:231], v[100:103]
    ds_read_b128 v[64:67], v17 offset:0
    v_accvgpr_read_b32 v56, a144
    v_mfma_f32_16x16x32_bf16 v[100:103], a[172:175], v[244:247], v[100:103]
    ds_read_b64 v[48:49], v2 offset:0
    v_accvgpr_read_b32 v57, a145
    v_mfma_f32_16x16x32_bf16 v[96:99], a[172:175], v[240:243], v[96:99]
    ds_read_b128 a[160:163], v10 offset:16384
    v_accvgpr_read_b32 v58, a148
    v_mfma_f32_16x16x32_bf16 v[96:99], a[168:171], v[224:227], v[96:99]
    ds_read_b128 v[68:71], v17 offset:1024
    s_waitcnt lgkmcnt(5)
    v_mfma_f32_16x16x32_bf16 a[128:131], a[176:179], v[224:227], a[128:131]
    ds_read_b64 v[50:51], v2 offset:512
    v_accvgpr_read_b32 v59, a149
    v_mfma_f32_16x16x32_bf16 a[128:131], a[180:183], v[240:243], a[128:131]
    ds_read_b128 v[72:75], v17 offset:2048
    ds_read_b128 v[76:79], v17 offset:3072
    v_cvt_pk_bf16_f32 v115, v105, v109
    v_mfma_f32_16x16x32_bf16 a[132:135], a[180:183], v[244:247], a[132:135]
    ds_write_b128 v16, a[64:67] offset:16384
    v_mfma_f32_16x16x32_bf16 a[132:135], a[176:179], v[228:231], a[132:135]
    s_add_u32 m0, m0, s73
    s_mul_i32 s71, s64, 9
    v_cvt_pk_bf16_f32 v113, v104, v108
    v_mfma_f32_16x16x32_bf16 a[136:139], a[176:179], v[232:235], a[136:139]
    ds_read_b128 a[164:167], v9 offset:20480
    v_cvt_pk_bf16_f32 v112, v96, v100
    v_mfma_f32_16x16x32_bf16 a[136:139], a[180:183], v[248:251], a[136:139]
    buffer_load_dwordx4 v6, s[4:7], s68 offen lds
    ds_read_b128 a[168:171], v10 offset:20480
    v_mfma_f32_16x16x32_bf16 a[140:143], a[180:183], v[252:255], a[140:143]
    ds_read_b64 v[52:53], v2 offset:1024
    ds_read_b64 v[54:55], v2 offset:1536
    v_mfma_f32_16x16x32_bf16 a[140:143], a[176:179], v[236:239], a[140:143]
    buffer_store_dwordx2 v[112:113], v18, s[12:15], s71 offen sc0 sc1
    s_waitcnt lgkmcnt(5)
    v_mfma_f32_16x16x32_bf16 v[64:67], a[184:187], v[128:131], v[64:67]
    ds_write_b128 v16, a[68:71] offset:17408
    v_mfma_f32_16x16x32_bf16 v[64:67], a[160:163], v[144:147], v[64:67]
    v_accvgpr_read_b32 v60, a152
    v_accvgpr_read_b32 v61, a153
    v_mfma_f32_16x16x32_bf16 v[68:71], a[160:163], v[148:151], v[68:71]
    v_accvgpr_read_b32 v62, a156
    v_accvgpr_read_b32 v63, a157
    v_mfma_f32_16x16x32_bf16 v[68:71], a[184:187], v[132:135], v[68:71]
    s_add_u32 m0, m0, 0x1000
    ds_write_b128 v16, a[72:75] offset:18432
    v_mfma_f32_16x16x32_bf16 v[72:75], a[184:187], v[136:139], v[72:75]
    buffer_load_dwordx4 v7, s[4:7], s68 offen lds
    v_mfma_f32_16x16x32_bf16 v[72:75], a[160:163], v[152:155], v[72:75]
    v_cvt_pk_bf16_f32 v114, v97, v101
    s_waitcnt lgkmcnt(2)
    v_add_f32 v54, v54, v62
    v_add_f32 v55, v55, v63
    v_mfma_f32_16x16x32_bf16 v[76:79], a[160:163], v[156:159], v[76:79]
    buffer_store_dwordx2 v[114:115], v19, s[12:15], s71 offen sc0 sc1
    v_cvt_pk_bf16_f32 v116, v98, v102
    v_mfma_f32_16x16x32_bf16 v[76:79], a[184:187], v[140:143], v[76:79]
    ds_read_b128 a[172:175], v9 offset:24576
    v_mfma_f32_16x16x32_bf16 v[76:79], a[164:167], v[172:175], v[76:79]
    ds_read_b128 a[176:179], v10 offset:24576
    v_cvt_pk_bf16_f32 v117, v106, v110
    v_mfma_f32_16x16x32_bf16 v[76:79], a[168:171], v[188:191], v[76:79]
    ds_read_b128 a[180:183], v9 offset:28672
    v_cvt_pk_bf16_f32 v118, v99, v103
    v_mfma_f32_16x16x32_bf16 v[72:75], a[168:171], v[184:187], v[72:75]
    s_add_u32 m0, m0, s73
    ds_write_b128 v16, a[76:79] offset:19456
    v_mfma_f32_16x16x32_bf16 v[72:75], a[164:167], v[168:171], v[72:75]
    buffer_load_dwordx4 v8, s[4:7], s68 offen lds
    v_mfma_f32_16x16x32_bf16 v[68:71], a[164:167], v[164:167], v[68:71]
    v_cvt_pk_bf16_f32 v119, v107, v111
    v_add_f32 v48, v48, v56
    v_mfma_f32_16x16x32_bf16 v[68:71], a[168:171], v[180:183], v[68:71]
    buffer_store_dwordx2 v[116:117], v20, s[12:15], s71 offen sc0 sc1
    v_add_f32 v49, v49, v57
    v_mfma_f32_16x16x32_bf16 v[64:67], a[168:171], v[176:179], v[64:67]
    ds_read_b128 a[184:187], v10 offset:28672
    v_add_f32 v50, v50, v58
    v_mfma_f32_16x16x32_bf16 v[64:67], a[164:167], v[160:163], v[64:67]
    v_add_f32 v51, v51, v59
    s_waitcnt lgkmcnt(3)
    v_mfma_f32_16x16x32_bf16 v[64:67], a[172:175], v[192:195], v[64:67]
    v_add_f32 v52, v52, v60
    v_add_f32 v53, v53, v61
    v_mfma_f32_16x16x32_bf16 v[64:67], a[176:179], v[208:211], v[64:67]
    ds_read_b128 a[160:163], v9 offset:32768
    s_add_u32 m0, m0, s73
    v_mfma_f32_16x16x32_bf16 v[68:71], a[176:179], v[212:215], v[68:71]
    buffer_load_dwordx4 v5, s[4:7], s69 offen lds
    v_mfma_f32_16x16x32_bf16 v[68:71], a[172:175], v[196:199], v[68:71]
    s_waitcnt vmcnt(15) lgkmcnt(2)
    s_barrier
    v_mfma_f32_16x16x32_bf16 v[72:75], a[172:175], v[200:203], v[72:75]
    buffer_store_dwordx2 v[118:119], v21, s[12:15], s71 offen sc0 sc1
    v_cvt_pk_bf16_f32 v56, v48, v50
    v_mfma_f32_16x16x32_bf16 v[72:75], a[176:179], v[216:219], v[72:75]
    ds_read_b128 v[80:83], v17 offset:16384
    v_cvt_pk_bf16_f32 v57, v52, v54
    v_mfma_f32_16x16x32_bf16 v[76:79], a[176:179], v[220:223], v[76:79]
    ds_read_b128 a[164:167], v10 offset:32768
    v_cvt_pk_bf16_f32 v58, v49, v51
    v_mfma_f32_16x16x32_bf16 v[76:79], a[172:175], v[204:207], v[76:79]
    ds_read_b128 v[84:87], v17 offset:17408
    s_waitcnt lgkmcnt(4)
    v_mfma_f32_16x16x32_bf16 v[76:79], a[180:183], v[236:239], v[76:79]
    ds_read_b128 v[88:91], v17 offset:18432
    v_cvt_pk_bf16_f32 v59, v53, v55
    v_mfma_f32_16x16x32_bf16 v[76:79], a[184:187], v[252:255], v[76:79]
    ds_read_b128 a[168:171], v9 offset:36864
    ds_read_b128 v[92:95], v17 offset:19456
    v_mfma_f32_16x16x32_bf16 v[72:75], a[184:187], v[248:251], v[72:75]
    ds_write_b128 v16, a[80:83] offset:32768
    v_mfma_f32_16x16x32_bf16 v[72:75], a[180:183], v[232:235], v[72:75]
    buffer_store_dwordx2 v[56:57], v18, s[16:19], s76 offen sc0 sc1
    v_mfma_f32_16x16x32_bf16 v[68:71], a[180:183], v[228:231], v[68:71]
    s_add_u32 m0, m0, s73
    v_mfma_f32_16x16x32_bf16 v[68:71], a[184:187], v[244:247], v[68:71]
    buffer_load_dwordx4 v6, s[4:7], s69 offen lds
    v_mfma_f32_16x16x32_bf16 v[64:67], a[184:187], v[240:243], v[64:67]
    ds_read_b128 a[172:175], v10 offset:36864
    v_mfma_f32_16x16x32_bf16 v[64:67], a[180:183], v[224:227], v[64:67]
    buffer_store_dwordx2 v[58:59], v19, s[16:19], s76 offen sc0 sc1
    s_waitcnt lgkmcnt(2)
    v_mfma_f32_16x16x32_bf16 v[80:83], a[160:163], v[128:131], v[80:83]
    ds_write_b128 v16, a[84:87] offset:33792
    v_mfma_f32_16x16x32_bf16 v[80:83], a[164:167], v[144:147], v[80:83]
    v_cvt_pk_bf16_f32 v121, v72, v76
    v_cvt_pk_bf16_f32 v123, v73, v77
    v_mfma_f32_16x16x32_bf16 v[84:87], a[164:167], v[148:151], v[84:87]
    v_cvt_pk_bf16_f32 v125, v74, v78
    v_cvt_pk_bf16_f32 v127, v75, v79
    v_mfma_f32_16x16x32_bf16 v[84:87], a[160:163], v[132:135], v[84:87]
    ds_read_b128 a[176:179], v9 offset:40960
    s_add_u32 m0, m0, s73
    v_mfma_f32_16x16x32_bf16 v[88:91], a[160:163], v[136:139], v[88:91]
    buffer_load_dwordx4 v7, s[4:7], s69 offen lds
    v_cvt_pk_bf16_f32 v120, v64, v68
    v_mfma_f32_16x16x32_bf16 v[88:91], a[164:167], v[152:155], v[88:91]
    s_mul_i32 s71, s65, 9
    ds_write_b128 v16, a[88:91] offset:34816
    v_mfma_f32_16x16x32_bf16 v[92:95], a[164:167], v[156:159], v[92:95]
    buffer_store_dwordx2 v[120:121], v18, s[12:15], s71 offen sc0 sc1
    v_cvt_pk_bf16_f32 v122, v65, v69
    v_mfma_f32_16x16x32_bf16 v[92:95], a[160:163], v[140:143], v[92:95]
    v_cvt_pk_bf16_f32 v124, v66, v70
    s_waitcnt lgkmcnt(3)
    v_mfma_f32_16x16x32_bf16 v[92:95], a[168:171], v[172:175], v[92:95]
    ds_read_b128 a[180:183], v10 offset:40960
    v_cvt_pk_bf16_f32 v126, v67, v71
    v_mfma_f32_16x16x32_bf16 v[92:95], a[172:175], v[188:191], v[92:95]
    ds_read_b128 a[184:187], v9 offset:45056
    v_mfma_f32_16x16x32_bf16 v[88:91], a[172:175], v[184:187], v[88:91]
    s_add_u32 m0, m0, 0x1000
    ds_write_b128 v16, a[92:95] offset:35840
    v_mfma_f32_16x16x32_bf16 v[88:91], a[168:171], v[168:171], v[88:91]
    buffer_load_dwordx4 v8, s[4:7], s69 offen lds
    v_mfma_f32_16x16x32_bf16 v[84:87], a[168:171], v[164:167], v[84:87]
    v_mfma_f32_16x16x32_bf16 v[84:87], a[172:175], v[180:183], v[84:87]
    buffer_store_dwordx2 v[122:123], v19, s[12:15], s71 offen sc0 sc1
    v_mfma_f32_16x16x32_bf16 v[80:83], a[172:175], v[176:179], v[80:83]
    ds_read_b128 a[160:163], v10 offset:45056
    v_mfma_f32_16x16x32_bf16 v[80:83], a[168:171], v[160:163], v[80:83]
    s_waitcnt lgkmcnt(3)
    v_mfma_f32_16x16x32_bf16 v[80:83], a[176:179], v[192:195], v[80:83]
    v_mfma_f32_16x16x32_bf16 v[80:83], a[180:183], v[208:211], v[80:83]
    ds_read_b128 a[164:167], v9 offset:49152
    s_mov_b32 m0, s72
    v_mfma_f32_16x16x32_bf16 v[84:87], a[180:183], v[212:215], v[84:87]
    buffer_load_dwordx4 v5, s[4:7], s70 offen lds
    v_mfma_f32_16x16x32_bf16 v[84:87], a[176:179], v[196:199], v[84:87]
    s_waitcnt vmcnt(16) lgkmcnt(2)
    s_barrier
    v_mfma_f32_16x16x32_bf16 v[88:91], a[176:179], v[200:203], v[88:91]
    buffer_store_dwordx2 v[124:125], v20, s[12:15], s71 offen sc0 sc1
    v_mfma_f32_16x16x32_bf16 v[88:91], a[180:183], v[216:219], v[88:91]
    ds_read_b128 v[96:99], v17 offset:32768
    v_mfma_f32_16x16x32_bf16 v[92:95], a[180:183], v[220:223], v[92:95]
    ds_read_b128 a[168:171], v10 offset:49152
    v_mfma_f32_16x16x32_bf16 v[92:95], a[176:179], v[204:207], v[92:95]
    ds_read_b128 v[100:103], v17 offset:33792
    s_waitcnt lgkmcnt(4)
    v_mfma_f32_16x16x32_bf16 v[92:95], a[184:187], v[236:239], v[92:95]
    ds_read_b128 v[104:107], v17 offset:34816
    v_mfma_f32_16x16x32_bf16 v[92:95], a[160:163], v[252:255], v[92:95]
    ds_read_b128 a[172:175], v9 offset:53248
    ds_read_b128 v[108:111], v17 offset:35840
    v_mfma_f32_16x16x32_bf16 v[88:91], a[160:163], v[248:251], v[88:91]
    ds_write_b128 v16, a[96:99] offset:0
    v_mfma_f32_16x16x32_bf16 v[88:91], a[184:187], v[232:235], v[88:91]
    buffer_store_dwordx2 v[126:127], v21, s[12:15], s71 offen sc0 sc1
    v_mfma_f32_16x16x32_bf16 v[84:87], a[184:187], v[228:231], v[84:87]
    v_mfma_f32_16x16x32_bf16 v[84:87], a[160:163], v[244:247], v[84:87]
    ds_read_b128 a[176:179], v10 offset:53248
    v_mfma_f32_16x16x32_bf16 v[80:83], a[160:163], v[240:243], v[80:83]
    v_mfma_f32_16x16x32_bf16 v[80:83], a[184:187], v[224:227], v[80:83]
    ds_read_b128 a[180:183], v9 offset:57344
    s_waitcnt lgkmcnt(3)
    v_mfma_f32_16x16x32_bf16 v[96:99], a[164:167], v[128:131], v[96:99]
    ds_write_b128 v16, a[100:103] offset:1024
    v_mfma_f32_16x16x32_bf16 v[96:99], a[168:171], v[144:147], v[96:99]
    v_cvt_pk_bf16_f32 v113, v88, v92
    v_cvt_pk_bf16_f32 v115, v89, v93
    v_mfma_f32_16x16x32_bf16 v[100:103], a[168:171], v[148:151], v[100:103]
    v_cvt_pk_bf16_f32 v117, v90, v94
    v_cvt_pk_bf16_f32 v119, v91, v95
    v_mfma_f32_16x16x32_bf16 v[100:103], a[164:167], v[132:135], v[100:103]
    ds_read_b128 a[184:187], v10 offset:57344
    s_add_u32 m0, m0, 0x1000
    v_mfma_f32_16x16x32_bf16 v[104:107], a[164:167], v[136:139], v[104:107]
    buffer_load_dwordx4 v6, s[4:7], s70 offen lds
    v_cvt_pk_bf16_f32 v112, v80, v84
    v_mfma_f32_16x16x32_bf16 v[104:107], a[168:171], v[152:155], v[104:107]
    s_mul_i32 s71, s66, 9
    ds_write_b128 v16, a[104:107] offset:2048
    v_mfma_f32_16x16x32_bf16 v[108:111], a[168:171], v[156:159], v[108:111]
    buffer_store_dwordx2 v[112:113], v18, s[12:15], s71 offen sc0 sc1
    v_cvt_pk_bf16_f32 v114, v81, v85
    v_mfma_f32_16x16x32_bf16 v[108:111], a[164:167], v[140:143], v[108:111]
    v_cvt_pk_bf16_f32 v116, v82, v86
    s_waitcnt lgkmcnt(4)
    v_mfma_f32_16x16x32_bf16 v[108:111], a[172:175], v[172:175], v[108:111]
    v_cvt_pk_bf16_f32 v118, v83, v87
    v_mfma_f32_16x16x32_bf16 v[108:111], a[176:179], v[188:191], v[108:111]
    ds_read_b128 a[160:163], v9 offset:61440
    v_mfma_f32_16x16x32_bf16 v[104:107], a[176:179], v[184:187], v[104:107]
    s_add_u32 m0, m0, 0x1000
    ds_write_b128 v16, a[108:111] offset:3072
    v_mfma_f32_16x16x32_bf16 v[104:107], a[172:175], v[168:171], v[104:107]
    buffer_load_dwordx4 v7, s[4:7], s70 offen lds
    v_mfma_f32_16x16x32_bf16 v[100:103], a[172:175], v[164:167], v[100:103]
    v_mfma_f32_16x16x32_bf16 v[100:103], a[176:179], v[180:183], v[100:103]
    buffer_store_dwordx2 v[114:115], v19, s[12:15], s71 offen sc0 sc1
    v_mfma_f32_16x16x32_bf16 v[96:99], a[176:179], v[176:179], v[96:99]
    ds_read_b128 a[164:167], v10 offset:61440
    v_mfma_f32_16x16x32_bf16 v[96:99], a[172:175], v[160:163], v[96:99]
    s_waitcnt lgkmcnt(4)
    v_mfma_f32_16x16x32_bf16 v[96:99], a[180:183], v[192:195], v[96:99]
    v_mfma_f32_16x16x32_bf16 v[96:99], a[184:187], v[208:211], v[96:99]
    ds_read_b128 a[168:171], v11 offset:0
    s_add_u32 m0, m0, s73
    v_mfma_f32_16x16x32_bf16 v[100:103], a[184:187], v[212:215], v[100:103]
    buffer_load_dwordx4 v8, s[4:7], s70 offen lds
    v_mfma_f32_16x16x32_bf16 v[100:103], a[180:183], v[196:199], v[100:103]
    s_waitcnt vmcnt(16) lgkmcnt(2)
    s_barrier
    v_mfma_f32_16x16x32_bf16 v[104:107], a[180:183], v[200:203], v[104:107]
    buffer_store_dwordx2 v[116:117], v20, s[12:15], s71 offen sc0 sc1
    v_mfma_f32_16x16x32_bf16 v[104:107], a[184:187], v[216:219], v[104:107]
    ds_read_b128 v[64:67], v17 offset:0
    v_mfma_f32_16x16x32_bf16 v[108:111], a[184:187], v[220:223], v[108:111]
    ds_read_b128 a[172:175], v12 offset:0
    v_mfma_f32_16x16x32_bf16 v[108:111], a[180:183], v[204:207], v[108:111]
    ds_read_b128 v[68:71], v17 offset:1024
    s_waitcnt lgkmcnt(4)
    v_mfma_f32_16x16x32_bf16 v[108:111], a[160:163], v[236:239], v[108:111]
    ds_read_b128 v[72:75], v17 offset:2048
    v_mfma_f32_16x16x32_bf16 v[108:111], a[164:167], v[252:255], v[108:111]
    ds_read_b128 a[176:179], v11 offset:4096
    ds_read_b128 v[76:79], v17 offset:3072
    v_mfma_f32_16x16x32_bf16 v[104:107], a[164:167], v[248:251], v[104:107]
    ds_write_b128 v16, a[112:115] offset:16384
    v_mfma_f32_16x16x32_bf16 v[104:107], a[160:163], v[232:235], v[104:107]
    buffer_store_dwordx2 v[118:119], v21, s[12:15], s71 offen sc0 sc1
    v_mfma_f32_16x16x32_bf16 v[100:103], a[160:163], v[228:231], v[100:103]
    v_mfma_f32_16x16x32_bf16 v[100:103], a[164:167], v[244:247], v[100:103]
    ds_read_b128 a[180:183], v12 offset:4096
    v_mfma_f32_16x16x32_bf16 v[96:99], a[164:167], v[240:243], v[96:99]
    v_mfma_f32_16x16x32_bf16 v[96:99], a[160:163], v[224:227], v[96:99]
    ds_read_b128 a[184:187], v11 offset:8192
    s_waitcnt lgkmcnt(3)
    v_mfma_f32_16x16x32_bf16 v[64:67], a[168:171], v[128:131], v[64:67]
    ds_write_b128 v16, a[116:119] offset:17408
    v_mfma_f32_16x16x32_bf16 v[64:67], a[172:175], v[144:147], v[64:67]
    v_cvt_pk_bf16_f32 v121, v104, v108
    v_cvt_pk_bf16_f32 v123, v105, v109
    v_mfma_f32_16x16x32_bf16 v[68:71], a[172:175], v[148:151], v[68:71]
    v_cvt_pk_bf16_f32 v125, v106, v110
    v_cvt_pk_bf16_f32 v127, v107, v111
    v_mfma_f32_16x16x32_bf16 v[68:71], a[168:171], v[132:135], v[68:71]
    ds_read_b128 a[160:163], v12 offset:8192
    v_mfma_f32_16x16x32_bf16 v[72:75], a[168:171], v[136:139], v[72:75]
    ds_write_b128 v16, a[120:123] offset:18432
    v_mfma_f32_16x16x32_bf16 v[72:75], a[172:175], v[152:155], v[72:75]
    s_mul_i32 s71, s67, 9
    v_cvt_pk_bf16_f32 v120, v96, v100
    v_cvt_pk_bf16_f32 v122, v97, v101
    v_mfma_f32_16x16x32_bf16 v[76:79], a[172:175], v[156:159], v[76:79]
    buffer_store_dwordx2 v[120:121], v18, s[12:15], s71 offen sc0 sc1
    v_cvt_pk_bf16_f32 v124, v98, v102
    v_mfma_f32_16x16x32_bf16 v[76:79], a[168:171], v[140:143], v[76:79]
    v_cvt_pk_bf16_f32 v126, v99, v103
    s_waitcnt lgkmcnt(4)
    v_mfma_f32_16x16x32_bf16 v[76:79], a[176:179], v[172:175], v[76:79]
    v_mfma_f32_16x16x32_bf16 v[76:79], a[180:183], v[188:191], v[76:79]
    ds_read_b128 a[164:167], v11 offset:12288
    v_mfma_f32_16x16x32_bf16 v[72:75], a[180:183], v[184:187], v[72:75]
    ds_write_b128 v16, a[124:127] offset:19456
    v_mfma_f32_16x16x32_bf16 v[72:75], a[176:179], v[168:171], v[72:75]
    v_mfma_f32_16x16x32_bf16 v[68:71], a[176:179], v[164:167], v[68:71]
    v_mfma_f32_16x16x32_bf16 v[68:71], a[180:183], v[180:183], v[68:71]
    buffer_store_dwordx2 v[122:123], v19, s[12:15], s71 offen sc0 sc1
    v_mfma_f32_16x16x32_bf16 v[64:67], a[180:183], v[176:179], v[64:67]
    ds_read_b128 a[168:171], v12 offset:12288
    v_mfma_f32_16x16x32_bf16 v[64:67], a[176:179], v[160:163], v[64:67]
    s_waitcnt lgkmcnt(4)
    v_mfma_f32_16x16x32_bf16 v[64:67], a[184:187], v[192:195], v[64:67]
    v_mfma_f32_16x16x32_bf16 v[64:67], a[160:163], v[208:211], v[64:67]
    ds_read_b128 a[172:175], v11 offset:16384
    v_mfma_f32_16x16x32_bf16 v[68:71], a[160:163], v[212:215], v[68:71]
    v_mfma_f32_16x16x32_bf16 v[68:71], a[184:187], v[196:199], v[68:71]
    s_waitcnt vmcnt(11) lgkmcnt(2)
    s_barrier
    v_mfma_f32_16x16x32_bf16 v[72:75], a[184:187], v[200:203], v[72:75]
    buffer_store_dwordx2 v[124:125], v20, s[12:15], s71 offen sc0 sc1
    v_mfma_f32_16x16x32_bf16 v[72:75], a[160:163], v[216:219], v[72:75]
    ds_read_b128 v[80:83], v17 offset:16384
    v_mfma_f32_16x16x32_bf16 v[76:79], a[160:163], v[220:223], v[76:79]
    ds_read_b128 a[176:179], v12 offset:16384
    v_mfma_f32_16x16x32_bf16 v[76:79], a[184:187], v[204:207], v[76:79]
    ds_read_b128 v[84:87], v17 offset:17408
    s_waitcnt lgkmcnt(4)
    v_mfma_f32_16x16x32_bf16 v[76:79], a[164:167], v[236:239], v[76:79]
    ds_read_b128 v[88:91], v17 offset:18432
    v_mfma_f32_16x16x32_bf16 v[76:79], a[168:171], v[252:255], v[76:79]
    ds_read_b128 a[180:183], v11 offset:20480
    ds_read_b128 v[92:95], v17 offset:19456
    v_mfma_f32_16x16x32_bf16 v[72:75], a[168:171], v[248:251], v[72:75]
    ds_write_b128 v16, a[128:131] offset:32768
    v_mfma_f32_16x16x32_bf16 v[72:75], a[164:167], v[232:235], v[72:75]
    buffer_store_dwordx2 v[126:127], v21, s[12:15], s71 offen sc0 sc1
    v_mfma_f32_16x16x32_bf16 v[68:71], a[164:167], v[228:231], v[68:71]
    v_mfma_f32_16x16x32_bf16 v[68:71], a[168:171], v[244:247], v[68:71]
    ds_read_b128 a[184:187], v12 offset:20480
    v_mfma_f32_16x16x32_bf16 v[64:67], a[168:171], v[240:243], v[64:67]
    v_mfma_f32_16x16x32_bf16 v[64:67], a[164:167], v[224:227], v[64:67]
    ds_read_b128 a[160:163], v11 offset:24576
    s_waitcnt lgkmcnt(3)
    v_mfma_f32_16x16x32_bf16 v[80:83], a[172:175], v[128:131], v[80:83]
    ds_write_b128 v16, a[132:135] offset:33792
    v_mfma_f32_16x16x32_bf16 v[80:83], a[176:179], v[144:147], v[80:83]
    v_cvt_pk_bf16_f32 v113, v72, v76
    v_cvt_pk_bf16_f32 v115, v73, v77
    v_mfma_f32_16x16x32_bf16 v[84:87], a[176:179], v[148:151], v[84:87]
    v_cvt_pk_bf16_f32 v117, v74, v78
    v_cvt_pk_bf16_f32 v119, v75, v79
    v_mfma_f32_16x16x32_bf16 v[84:87], a[172:175], v[132:135], v[84:87]
    ds_read_b128 a[164:167], v12 offset:24576
    v_mfma_f32_16x16x32_bf16 v[88:91], a[172:175], v[136:139], v[88:91]
    ds_write_b128 v16, a[136:139] offset:34816
    v_mfma_f32_16x16x32_bf16 v[88:91], a[176:179], v[152:155], v[88:91]
    s_mul_i32 s71, s68, 9
    v_cvt_pk_bf16_f32 v112, v64, v68
    v_cvt_pk_bf16_f32 v114, v65, v69
    v_mfma_f32_16x16x32_bf16 v[92:95], a[176:179], v[156:159], v[92:95]
    buffer_store_dwordx2 v[112:113], v18, s[12:15], s71 offen sc0 sc1
    v_cvt_pk_bf16_f32 v116, v66, v70
    v_mfma_f32_16x16x32_bf16 v[92:95], a[172:175], v[140:143], v[92:95]
    v_cvt_pk_bf16_f32 v118, v67, v71
    s_waitcnt lgkmcnt(4)
    v_mfma_f32_16x16x32_bf16 v[92:95], a[180:183], v[172:175], v[92:95]
    v_mfma_f32_16x16x32_bf16 v[92:95], a[184:187], v[188:191], v[92:95]
    ds_read_b128 a[168:171], v11 offset:28672
    v_mfma_f32_16x16x32_bf16 v[88:91], a[184:187], v[184:187], v[88:91]
    ds_write_b128 v16, a[140:143] offset:35840
    v_mfma_f32_16x16x32_bf16 v[88:91], a[180:183], v[168:171], v[88:91]
    v_mfma_f32_16x16x32_bf16 v[84:87], a[180:183], v[164:167], v[84:87]
    v_mfma_f32_16x16x32_bf16 v[84:87], a[184:187], v[180:183], v[84:87]
    buffer_store_dwordx2 v[114:115], v19, s[12:15], s71 offen sc0 sc1
    v_mfma_f32_16x16x32_bf16 v[80:83], a[184:187], v[176:179], v[80:83]
    ds_read_b128 a[172:175], v12 offset:28672
    v_mfma_f32_16x16x32_bf16 v[80:83], a[180:183], v[160:163], v[80:83]
    s_waitcnt lgkmcnt(4)
    v_mfma_f32_16x16x32_bf16 v[80:83], a[160:163], v[192:195], v[80:83]
    v_mfma_f32_16x16x32_bf16 v[80:83], a[164:167], v[208:211], v[80:83]
    ds_read_b128 a[176:179], v9 offset:0
    v_mfma_f32_16x16x32_bf16 v[84:87], a[164:167], v[212:215], v[84:87]
    v_mfma_f32_16x16x32_bf16 v[84:87], a[160:163], v[196:199], v[84:87]
    s_waitcnt vmcnt(8) lgkmcnt(2)
    s_barrier
    v_mfma_f32_16x16x32_bf16 v[88:91], a[160:163], v[200:203], v[88:91]
    buffer_store_dwordx2 v[116:117], v20, s[12:15], s71 offen sc0 sc1
    v_mfma_f32_16x16x32_bf16 v[88:91], a[164:167], v[216:219], v[88:91]
    ds_read_b128 v[96:99], v17 offset:32768
    v_mfma_f32_16x16x32_bf16 v[92:95], a[164:167], v[220:223], v[92:95]
    ds_read_b128 a[180:183], v10 offset:0
    v_mfma_f32_16x16x32_bf16 v[92:95], a[160:163], v[204:207], v[92:95]
    ds_read_b128 v[100:103], v17 offset:33792
    s_waitcnt lgkmcnt(4)
    v_mfma_f32_16x16x32_bf16 v[92:95], a[168:171], v[236:239], v[92:95]
    ds_read_b128 v[104:107], v17 offset:34816
    v_mfma_f32_16x16x32_bf16 v[92:95], a[172:175], v[252:255], v[92:95]
    ds_read_b128 a[184:187], v9 offset:4096
    v_mfma_f32_16x16x32_bf16 v[88:91], a[172:175], v[248:251], v[88:91]
    ds_read_b128 v[108:111], v17 offset:35840
    v_mfma_f32_16x16x32_bf16 v[88:91], a[168:171], v[232:235], v[88:91]
    buffer_store_dwordx2 v[118:119], v21, s[12:15], s71 offen sc0 sc1
    v_mfma_f32_16x16x32_bf16 v[84:87], a[168:171], v[228:231], v[84:87]
    v_mfma_f32_16x16x32_bf16 v[84:87], a[172:175], v[244:247], v[84:87]
    ds_read_b128 a[160:163], v10 offset:4096
    v_mfma_f32_16x16x32_bf16 v[80:83], a[172:175], v[240:243], v[80:83]
    v_mfma_f32_16x16x32_bf16 v[80:83], a[168:171], v[224:227], v[80:83]
    s_waitcnt lgkmcnt(1)
    v_mfma_f32_16x16x32_bf16 v[96:99], a[176:179], v[128:131], v[96:99]
    v_mfma_f32_16x16x32_bf16 v[96:99], a[180:183], v[144:147], v[96:99]
    ds_read_b128 a[164:167], v9 offset:8192
    v_cvt_pk_bf16_f32 v121, v88, v92
    v_mfma_f32_16x16x32_bf16 v[100:103], a[180:183], v[148:151], v[100:103]
    v_cvt_pk_bf16_f32 v123, v89, v93
    v_cvt_pk_bf16_f32 v125, v90, v94
    v_mfma_f32_16x16x32_bf16 v[100:103], a[176:179], v[132:135], v[100:103]
    v_cvt_pk_bf16_f32 v127, v91, v95
    v_mfma_f32_16x16x32_bf16 v[104:107], a[176:179], v[136:139], v[104:107]
    v_cvt_pk_bf16_f32 v120, v80, v84
    v_cvt_pk_bf16_f32 v122, v81, v85
    v_mfma_f32_16x16x32_bf16 v[104:107], a[180:183], v[152:155], v[104:107]
    ds_read_b128 a[168:171], v10 offset:8192
    s_mul_i32 s71, s69, 9
    v_mfma_f32_16x16x32_bf16 v[108:111], a[180:183], v[156:159], v[108:111]
    buffer_store_dwordx2 v[120:121], v18, s[12:15], s71 offen sc0 sc1
    v_cvt_pk_bf16_f32 v124, v82, v86
    v_mfma_f32_16x16x32_bf16 v[108:111], a[176:179], v[140:143], v[108:111]
    v_cvt_pk_bf16_f32 v126, v83, v87
    s_waitcnt lgkmcnt(2)
L_pg3_standalone__normalfloat_lut_nf4__prompt_kernel:
.if (L_pg3_standalone__normalfloat_lut_nf4__prompt_kernel-L_pg0_standalone__normalfloat_lut_nf4__prompt_kernel) != 12296
.error "size model"
.endif
    s_cbranch_execz L_ret_standalone__normalfloat_lut_nf4__prompt_kernel
    v_mfma_f32_16x16x32_bf16 v[108:111], a[184:187], v[172:175], v[108:111]
    v_mfma_f32_16x16x32_bf16 v[108:111], a[160:163], v[188:191], v[108:111]
    ds_read_b128 a[172:175], v9 offset:12288
    v_mfma_f32_16x16x32_bf16 v[104:107], a[160:163], v[184:187], v[104:107]
    v_mfma_f32_16x16x32_bf16 v[104:107], a[184:187], v[168:171], v[104:107]
    v_mfma_f32_16x16x32_bf16 v[100:103], a[184:187], v[164:167], v[100:103]
    ds_read_b128 a[176:179], v10 offset:12288
    v_mfma_f32_16x16x32_bf16 v[100:103], a[160:163], v[180:183], v[100:103]
    buffer_store_dwordx2 v[122:123], v19, s[12:15], s71 offen sc0 sc1
    v_mfma_f32_16x16x32_bf16 v[96:99], a[160:163], v[176:179], v[96:99]
    v_mfma_f32_16x16x32_bf16 v[96:99], a[184:187], v[160:163], v[96:99]
    s_waitcnt lgkmcnt(2)
    v_mfma_f32_16x16x32_bf16 v[96:99], a[164:167], v[192:195], v[96:99]
    v_mfma_f32_16x16x32_bf16 v[96:99], a[168:171], v[208:211], v[96:99]
    v_mfma_f32_16x16x32_bf16 v[100:103], a[168:171], v[212:215], v[100:103]
    v_mfma_f32_16x16x32_bf16 v[100:103], a[164:167], v[196:199], v[100:103]
    v_mfma_f32_16x16x32_bf16 v[104:107], a[164:167], v[200:203], v[104:107]
    buffer_store_dwordx2 v[124:125], v20, s[12:15], s71 offen sc0 sc1
    v_mfma_f32_16x16x32_bf16 v[104:107], a[168:171], v[216:219], v[104:107]
    v_mfma_f32_16x16x32_bf16 v[108:111], a[168:171], v[220:223], v[108:111]
    v_mfma_f32_16x16x32_bf16 v[108:111], a[164:167], v[204:207], v[108:111]
    s_waitcnt lgkmcnt(0)
    v_mfma_f32_16x16x32_bf16 v[108:111], a[172:175], v[236:239], v[108:111]
    v_mfma_f32_16x16x32_bf16 v[108:111], a[176:179], v[252:255], v[108:111]
    v_mfma_f32_16x16x32_bf16 v[104:107], a[176:179], v[248:251], v[104:107]
    v_mfma_f32_16x16x32_bf16 v[104:107], a[172:175], v[232:235], v[104:107]
    buffer_store_dwordx2 v[126:127], v21, s[12:15], s71 offen sc0 sc1
    v_mfma_f32_16x16x32_bf16 v[100:103], a[172:175], v[228:231], v[100:103]
    v_mfma_f32_16x16x32_bf16 v[100:103], a[176:179], v[244:247], v[100:103]
    v_mfma_f32_16x16x32_bf16 v[96:99], a[176:179], v[240:243], v[96:99]
    v_mfma_f32_16x16x32_bf16 v[96:99], a[172:175], v[224:227], v[96:99]
    s_nop 2
    v_cvt_pk_bf16_f32 v113, v104, v108
    v_cvt_pk_bf16_f32 v115, v105, v109
    v_cvt_pk_bf16_f32 v117, v106, v110
    v_cvt_pk_bf16_f32 v119, v107, v111
    s_mul_i32 s71, s70, 9
    v_cvt_pk_bf16_f32 v112, v96, v100
    v_cvt_pk_bf16_f32 v114, v97, v101
    v_cvt_pk_bf16_f32 v116, v98, v102
    v_cvt_pk_bf16_f32 v118, v99, v103
    buffer_store_dwordx2 v[112:113], v18, s[12:15], s71 offen sc0 sc1
    buffer_store_dwordx2 v[114:115], v19, s[12:15], s71 offen sc0 sc1
    buffer_store_dwordx2 v[116:117], v20, s[12:15], s71 offen sc0 sc1
    buffer_store_dwordx2 v[118:119], v21, s[12:15], s71 offen sc0 sc1
L_end_standalone__normalfloat_lut_nf4__prompt_kernel:
    s_endpgm
    .fill 512, 4, 0xbf810000
.section .rodata,"a"
.p2align 6
.amdhsa_kernel standalone__normalfloat_lut_nf4__prompt_kernel
  .amdhsa_next_free_vgpr 512
  .amdhsa_next_free_sgpr 102
  .amdhsa_accum_offset 256
  .amdhsa_group_segment_fixed_size 0
  .amdhsa_kernarg_size 48
  .amdhsa_user_sgpr_count 2
  .amdhsa_user_sgpr_kernarg_segment_ptr 1
  .amdhsa_system_sgpr_workgroup_id_x 1
  .amdhsa_float_denorm_mode_32 3
.end_amdhsa_kernel
```
